```python
import torch

def _softmax(x, axis=-1):
    return torch.softmax(x, dim=axis)
def _gelu(x):
    return torch.nn.functional.gelu(x, approximate="tanh")
def _silu(x):
    return torch.nn.functional.silu(x)
def _sigmoid(x):
    return torch.sigmoid(x)
def _layernorm(x, axis=-1, eps=1e-5):
    m = x.mean(dim=axis, keepdim=True)
    v = x.var(dim=axis, keepdim=True, unbiased=False)
    return (x - m) / torch.sqrt(v + eps)
def _scatter_add(tgt, idx, src, axis=0):
    return tgt.clone().index_add_(axis, idx, src)
def _segment_sum(src, seg, n):
    out = torch.zeros((n,) + src.shape[1:], dtype=src.dtype)
    return out.index_add_(0, seg, src)
def _pad(x, pw):
    flat = tuple(v for pair in reversed(pw) for v in pair)
    return torch.nn.functional.pad(x, flat)

kernel_name = 'recurrent_scan__mha_block_cached__dense_activation_squared_relu__decode'

def setup_inputs():

    _w = (lambda a: (lambda t: t.to(torch.bfloat16) if t.is_floating_point() else t)(torch.as_tensor(a)))
    def _A_setup():
        B, Sq, D = 2, 1, 640
        H, Sk, Dh = 32, 8192, 128
        return {
            "x": _w((lambda *s: torch.randn(*s, dtype=torch.bfloat16) * 0.05)(B, Sq, D)),
            "k_cache": _w((lambda *s: torch.randn(*s, dtype=torch.bfloat16) * 0.8)(B, H, Sk, Dh)),
            "v_cache": _w((lambda *s: torch.randn(*s, dtype=torch.bfloat16) * 0.2)(B, H, Sk, Dh)),
            "wq": _w((lambda *s: torch.randn(*s, dtype=torch.bfloat16) * 0.8)(D, H * Dh) * (D ** -0.5)),
            "wo": _w((lambda *s: torch.randn(*s, dtype=torch.bfloat16) * 0.2)(H * Dh, D) * ((H * Dh) ** -0.5)),
        }
    _A_in = _A_setup()

    def _B_setup():
        B, S, D, F = 2, 1, 640, 1728
        return {
            "x": _w((lambda *s: torch.randn(*s, dtype=torch.bfloat16) * 0.05)(B, S, D)),
            "w1": _w((lambda *s: torch.randn(*s, dtype=torch.bfloat16) * 0.1)(D, F)),
            "b1": _w((lambda *s: torch.randn(*s, dtype=torch.bfloat16) * 0.1)(F)),
            "w2": _w((lambda *s: torch.randn(*s, dtype=torch.bfloat16) * 0.1)(F, D)),
            "b2": _w((lambda *s: torch.randn(*s, dtype=torch.bfloat16) * 0.1)(D)),
        }
    _B_in = _B_setup()

    return {
        "A_x": _A_in["x"],
        "A_k_cache": _A_in["k_cache"],
        "A_v_cache": _A_in["v_cache"],
        "A_wq": _A_in["wq"],
        "A_wo": _A_in["wo"],
        "B_x": _B_in["x"],
        "B_w1": _B_in["w1"],
        "B_b1": _B_in["b1"],
        "B_w2": _B_in["w2"],
        "B_b2": _B_in["b2"],
    }

def reference(A_x, A_k_cache, A_v_cache, A_wq, A_wo, B_x, B_w1, B_b1, B_w2, B_b2):
    def _A_ref(x, k_cache, v_cache, wq, wo):
        B, Sq, D = x.shape
        H, Dh = 32, 128
        q = (lambda x, *d: x.permute(*d))((x @ wq).reshape(B, Sq, H, Dh), 0, 2, 1, 3)
        scores = torch.einsum("bhqd,bhkd->bhqk", q, k_cache) * (Dh ** -0.5)
        p = _softmax(scores, axis=-1)
        o = torch.einsum("bhqk,bhkd->bhqd", p, v_cache)
        return (lambda x, *d: x.permute(*d))(o, 0, 2, 1, 3).reshape(B, Sq, H * Dh) @ wo

    def _B_ref(x, w1, b1, w2, b2):
        h = torch.einsum("bsd,df->bsf", x, w1) + b1
        zero = torch.zeros_like(h)
        r = torch.where(h > zero, h, zero)
        h = r * r
        out = torch.einsum("bsf,fd->bsd", h, w2) + b2
        return out

    x = A_x
    xn = _layernorm(x, axis=-1)
    s = _A_ref(xn, A_k_cache, A_v_cache, A_wq, A_wo)
    g = _silu(_B_ref(xn, B_w1, B_b1, B_w2, B_b2))
    return x + s * g
```

```asm
; @launch grid=(256,1,1) block=(512,1,1) lds=12352
.amdgcn_target "amdgcn-amd-amdhsa--gfx950"
.text
.globl recurrent_scan__mha_block_cached__dense_activation_squared_relu__decode_kernel
.p2align 8
.type recurrent_scan__mha_block_cached__dense_activation_squared_relu__decode_kernel,@function
recurrent_scan__mha_block_cached__dense_activation_squared_relu__decode_kernel:
  s_cmp_ge_u32 s2, 256
  s_cbranch_scc1 L_exit
  s_load_dwordx16 s[16:31], s[0:1], 0
  s_load_dwordx8 s[32:39], s[0:1], 64
  s_load_dwordx2 s[40:41], s[0:1], 96
  v_lshrrev_b32 v1, 6, v0
  v_and_b32 v0, 63, v0
  v_readfirstlane_b32 s3, v1
  s_and_b32 s4, s2, 7
  s_lshr_b32 s5, s2, 3
  s_lshr_b32 s6, s5, 3
  s_lshl_b32 s7, s4, 2
  s_add_u32 s6, s6, s7
  s_bfe_u32 s7, s5, 0x10002
  s_and_b32 s8, s5, 3
  s_and_b32 s5, s5, 7
  s_lshl_b32 s9, s7, 5
  s_add_u32 s9, s9, s6
  s_and_b32 s10, s3, 3
  s_cmp_ge_u32 s3, 4
  s_cbranch_scc0 L_helper
  v_lshlrev_b32 v1, 4, v0
  s_lshl_b32 s56, s10, 12
  s_bfe_u32 s14, s8, 0x10000
  s_lshl_b32 s14, s14, 14
  s_or_b32 s56, s56, s14
  s_bfe_u32 s14, s8, 0x10001
  s_lshl_b32 s14, s14, 15
  s_or_b32 s56, s56, s14
  s_bitcmp1_b32 s9, 5
  s_cselect_b32 s14, 262144, 0
  s_xor_b32 s56, s56, s14
  s_mov_b32 s57, 0
  s_xor_b32 s13, s56, s57
  s_lshl_b32 s11, s9, 21
  s_mov_b32 s46, 0x200000
  s_mov_b32 s47, 0x20000
  s_waitcnt lgkmcnt(0)
  s_add_u32 s44, s18, s11
  s_addc_u32 s45, s19, 0
  buffer_load_dwordx4 v[64:67], v1, s[44:47], s13 offen offset:0 nt
  buffer_load_dwordx4 v[68:71], v1, s[44:47], s13 offen offset:1024 nt
  buffer_load_dwordx4 v[72:75], v1, s[44:47], s13 offen offset:2048 nt
  buffer_load_dwordx4 v[76:79], v1, s[44:47], s13 offen offset:3072 nt
  s_xor_b32 s13, s13, 0x40000
  s_add_u32 s48, s20, s11
  s_addc_u32 s49, s21, 0
  s_load_dword s60, s[40:41], 1007616
  s_lshl_b32 s14, s4, 2
  s_add_u32 s14, s14, s10
  s_lshl_b32 s14, s14, 7
  s_add_u32 s14, s14, 1007744
  s_add_u32 s58, s40, s14
  s_addc_u32 s59, s41, 0
  v_and_b32 v54, 31, v0
  v_lshlrev_b32 v54, 2, v54
  s_lshr_b32 s14, s2, 3
  s_lshl_b32 s14, s14, 2
  v_mov_b32 v55, s14
  v_and_b32 v2, 1, v0
  v_lshlrev_b32 v2, 4, v2
  v_mov_b32 v3, 0xffff
  v_lshlrev_b32 v3, v2, v3
  v_bfe_u32 v2, v0, 1, 2
  v_cmp_eq_u32 vcc, 0, v2
  s_nop 1
  v_cndmask_b32 v6, 0, v3, vcc
  v_cmp_eq_u32 vcc, 1, v2
  s_nop 1
  v_cndmask_b32 v7, 0, v3, vcc
  v_cmp_eq_u32 vcc, 2, v2
  s_nop 1
  v_cndmask_b32 v8, 0, v3, vcc
  v_cmp_eq_u32 vcc, 3, v2
  s_nop 1
  v_cndmask_b32 v9, 0, v3, vcc
  s_mov_b64 vcc, 0
  s_mov_b32 s71, 0
  s_sub_u32 s64, s2, 112
  s_cmp_lt_u32 s64, 135
  s_cselect_b32 s65, 1, 5
  s_cmp_eq_u32 s10, s65
  s_cselect_b32 s71, 2, 0
  s_mov_b32 s14, 3
  s_mov_b32 s50, 0xcccccccc
  s_mov_b32 s51, 0xcccccccc
  s_mov_b32 s52, 0xaaaaaaaa
  s_mov_b32 s53, 0xaaaaaaaa
  v_and_b32 v28, 15, v0
  v_lshlrev_b32 v28, 5, v28
  buffer_load_dwordx4 v[80:83], v1, s[44:47], s13 offen offset:0 nt
  s_waitcnt vmcnt(4)
  buffer_load_dwordx4 v[84:87], v1, s[44:47], s13 offen offset:1024 nt
  s_waitcnt vmcnt(4)
  buffer_load_dwordx4 v[88:91], v1, s[44:47], s13 offen offset:2048 nt
  s_waitcnt vmcnt(4)
  buffer_load_dwordx4 v[92:95], v1, s[44:47], s13 offen offset:3072 nt
  s_xor_b32 s13, s13, 0x50000
  s_waitcnt vmcnt(4)
  buffer_load_dwordx4 v[96:99], v1, s[44:47], s13 offen offset:0 nt
  s_waitcnt vmcnt(4)
  buffer_load_dwordx4 v[100:103], v1, s[44:47], s13 offen offset:1024 nt
  s_waitcnt vmcnt(4)
  buffer_load_dwordx4 v[104:107], v1, s[44:47], s13 offen offset:2048 nt
  s_waitcnt vmcnt(4)
  buffer_load_dwordx4 v[108:111], v1, s[44:47], s13 offen offset:3072 nt
  s_xor_b32 s13, s13, 0x40000
  s_waitcnt lgkmcnt(0)
  s_add_u32 s60, s60, 1
  s_lshl_b32 s60, s60, 8
  s_add_u32 s61, s60, 64
  v_mov_b32 v52, s60
  s_waitcnt vmcnt(9)
  v_subrev_u32 v53, s61, v52
  v_cmp_gt_u32 vcc, 64, v53
  s_add_u32 s60, s60, 1
  v_mov_b32 v53, s60
  s_bcnt1_i32_b32 s62, vcc_lo
  s_add_u32 s61, s60, 0
  global_load_dword v52, v54, s[58:59] sc0
  s_mov_b64 exec, 1
  global_store_dword v55, v53, s[58:59]
  s_mov_b64 exec, -1
  s_cmp_ge_u32 s62, 28
  s_cselect_b64 vcc, -1, 0
  s_waitcnt vmcnt(6)
  buffer_load_dwordx4 v[112:115], v1, s[44:47], s13 offen offset:0 nt
  s_waitcnt vmcnt(6)
  buffer_load_dwordx4 v[116:119], v1, s[44:47], s13 offen offset:1024 nt
  s_waitcnt vmcnt(6)
  buffer_load_dwordx4 v[120:123], v1, s[44:47], s13 offen offset:2048 nt
  s_waitcnt vmcnt(6)
  buffer_load_dwordx4 v[124:127], v1, s[44:47], s13 offen offset:3072 nt
  s_or_b32 s57, s57, 0xffe5ffff
  s_add_u32 s57, s57, 1
  s_and_b32 s57, s57, 0x1a0000
  s_xor_b32 s13, s56, s57
  s_cbranch_vccnz L_c1
  s_waitcnt vmcnt(6)
L_c1:
  s_waitcnt vmcnt(8)
  buffer_load_dwordx4 v[128:131], v1, s[44:47], s13 offen offset:0 nt
  s_cbranch_vccnz L_c2
  s_waitcnt vmcnt(4)
L_c2:
  s_waitcnt vmcnt(8)
  buffer_load_dwordx4 v[132:135], v1, s[44:47], s13 offen offset:1024 nt
  s_cbranch_vccnz L_c3
  s_waitcnt vmcnt(4)
L_c3:
  s_waitcnt vmcnt(8)
  buffer_load_dwordx4 v[136:139], v1, s[44:47], s13 offen offset:2048 nt
  s_cbranch_vccnz L_c4
  s_waitcnt vmcnt(4)
L_c4:
  s_waitcnt vmcnt(6)
  buffer_load_dwordx4 v[140:143], v1, s[44:47], s13 offen offset:3072 nt
  s_xor_b32 s13, s13, 0x40000
  s_waitcnt vmcnt(9)
  v_subrev_u32 v53, s61, v52
  v_cmp_gt_u32 vcc, 64, v53
  s_add_u32 s60, s60, 1
  v_mov_b32 v53, s60
  s_bcnt1_i32_b32 s62, vcc_lo
  s_add_u32 s61, s60, 0
  global_load_dword v52, v54, s[58:59] sc0
  s_mov_b64 exec, 1
  global_store_dword v55, v53, s[58:59]
  s_mov_b64 exec, -1
  s_cmp_ge_u32 s62, 28
  s_cselect_b64 vcc, -1, 0
  s_cbranch_vccnz L_c5
  s_waitcnt vmcnt(6)
L_c5:
  s_waitcnt vmcnt(8)
  buffer_load_dwordx4 v[144:147], v1, s[44:47], s13 offen offset:0 nt
  s_cbranch_vccnz L_c6
  s_waitcnt vmcnt(6)
L_c6:
  s_waitcnt vmcnt(8)
  buffer_load_dwordx4 v[148:151], v1, s[44:47], s13 offen offset:1024 nt
  s_cbranch_vccnz L_c7
  s_waitcnt vmcnt(6)
L_c7:
  s_waitcnt vmcnt(8)
  buffer_load_dwordx4 v[152:155], v1, s[44:47], s13 offen offset:2048 nt
  s_cbranch_vccnz L_c8
  s_waitcnt vmcnt(6)
L_c8:
  s_waitcnt vmcnt(8)
  buffer_load_dwordx4 v[156:159], v1, s[44:47], s13 offen offset:3072 nt
  s_xor_b32 s13, s13, 0x50000
  s_cbranch_vccnz L_c9
  s_waitcnt vmcnt(6)
L_c9:
  s_waitcnt vmcnt(8)
  buffer_load_dwordx4 v[160:163], v1, s[44:47], s13 offen offset:0 nt
  s_cbranch_vccnz L_c10
  s_waitcnt vmcnt(4)
L_c10:
  s_waitcnt vmcnt(8)
  buffer_load_dwordx4 v[164:167], v1, s[44:47], s13 offen offset:1024 nt
  s_cbranch_vccnz L_c11
  s_waitcnt vmcnt(4)
L_c11:
  s_waitcnt vmcnt(8)
  buffer_load_dwordx4 v[168:171], v1, s[44:47], s13 offen offset:2048 nt
  s_cbranch_vccnz L_c12
  s_waitcnt vmcnt(4)
L_c12:
  s_waitcnt vmcnt(6)
  buffer_load_dwordx4 v[172:175], v1, s[44:47], s13 offen offset:3072 nt
  s_xor_b32 s13, s13, 0x40000
  s_waitcnt vmcnt(9)
  v_subrev_u32 v53, s61, v52
  v_cmp_gt_u32 vcc, 64, v53
  s_add_u32 s60, s60, 1
  v_mov_b32 v53, s60
  s_bcnt1_i32_b32 s62, vcc_lo
  s_add_u32 s61, s60, 0
  global_load_dword v52, v54, s[58:59] sc0
  s_mov_b64 exec, 1
  global_store_dword v55, v53, s[58:59]
  s_mov_b64 exec, -1
  s_cmp_ge_u32 s62, 28
  s_cselect_b64 vcc, -1, 0
  s_cbranch_vccnz L_c13
  s_waitcnt vmcnt(6)
L_c13:
  s_waitcnt vmcnt(8)
  buffer_load_dwordx4 v[176:179], v1, s[44:47], s13 offen offset:0 nt
  s_cbranch_vccnz L_c14
  s_waitcnt vmcnt(6)
L_c14:
  s_waitcnt vmcnt(8)
  buffer_load_dwordx4 v[180:183], v1, s[44:47], s13 offen offset:1024 nt
  s_cbranch_vccnz L_c15
  s_waitcnt vmcnt(6)
L_c15:
  s_waitcnt vmcnt(8)
  buffer_load_dwordx4 v[184:187], v1, s[44:47], s13 offen offset:2048 nt
  s_cbranch_vccnz L_c16
  s_waitcnt vmcnt(6)
L_c16:
  s_waitcnt vmcnt(8)
  buffer_load_dwordx4 v[188:191], v1, s[44:47], s13 offen offset:3072 nt
  s_or_b32 s57, s57, 0xffe5ffff
  s_add_u32 s57, s57, 1
  s_and_b32 s57, s57, 0x1a0000
  s_xor_b32 s13, s56, s57
  s_barrier
  s_cbranch_vccnz L_c17
  s_waitcnt vmcnt(6)
L_c17:
  s_waitcnt vmcnt(8)
  buffer_load_dwordx4 v[192:195], v1, s[44:47], s13 offen offset:0 nt
  s_cbranch_vccnz L_c18
  s_waitcnt vmcnt(4)
L_c18:
  s_waitcnt vmcnt(8)
  buffer_load_dwordx4 v[196:199], v1, s[44:47], s13 offen offset:1024 nt
  s_cbranch_vccnz L_c19
  s_waitcnt vmcnt(4)
L_c19:
  s_waitcnt vmcnt(8)
  buffer_load_dwordx4 v[200:203], v1, s[44:47], s13 offen offset:2048 nt
  s_cbranch_vccnz L_c20
  s_waitcnt vmcnt(4)
L_c20:
  s_waitcnt vmcnt(6)
  buffer_load_dwordx4 v[204:207], v1, s[44:47], s13 offen offset:3072 nt
  s_xor_b32 s13, s13, 0x40000
  s_waitcnt vmcnt(9)
  v_subrev_u32 v53, s61, v52
  v_cmp_gt_u32 vcc, 64, v53
  s_add_u32 s60, s60, 1
  v_mov_b32 v53, s60
  s_bcnt1_i32_b32 s62, vcc_lo
  s_add_u32 s61, s60, 0
  global_load_dword v52, v54, s[58:59] sc0
  s_mov_b64 exec, 1
  global_store_dword v55, v53, s[58:59]
  s_mov_b64 exec, -1
  s_cmp_ge_u32 s62, 28
  s_cselect_b64 vcc, -1, 0
  s_cbranch_vccnz L_c21
  s_waitcnt vmcnt(6)
L_c21:
  s_waitcnt vmcnt(8)
  buffer_load_dwordx4 v[208:211], v1, s[44:47], s13 offen offset:0 nt
  s_cbranch_vccnz L_c22
  s_waitcnt vmcnt(6)
L_c22:
  s_waitcnt vmcnt(8)
  buffer_load_dwordx4 v[212:215], v1, s[44:47], s13 offen offset:1024 nt
  s_cbranch_vccnz L_c23
  s_waitcnt vmcnt(6)
L_c23:
  s_waitcnt vmcnt(8)
  buffer_load_dwordx4 v[216:219], v1, s[44:47], s13 offen offset:2048 nt
  s_cbranch_vccnz L_c24
  s_waitcnt vmcnt(6)
L_c24:
  s_waitcnt vmcnt(8)
  buffer_load_dwordx4 v[220:223], v1, s[44:47], s13 offen offset:3072 nt
  s_xor_b32 s13, s13, 0x50000
  s_cbranch_vccnz L_c25
  s_waitcnt vmcnt(6)
L_c25:
  s_waitcnt vmcnt(8)
  buffer_load_dwordx4 v[224:227], v1, s[44:47], s13 offen offset:0 nt
  s_cbranch_vccnz L_c26
  s_waitcnt vmcnt(4)
L_c26:
  s_waitcnt vmcnt(8)
  buffer_load_dwordx4 v[228:231], v1, s[44:47], s13 offen offset:1024 nt
  s_cbranch_vccnz L_c27
  s_waitcnt vmcnt(4)
L_c27:
  s_waitcnt vmcnt(8)
  buffer_load_dwordx4 v[232:235], v1, s[44:47], s13 offen offset:2048 nt
  s_cbranch_vccnz L_c28
  s_waitcnt vmcnt(4)
L_c28:
  s_waitcnt vmcnt(6)
  buffer_load_dwordx4 v[236:239], v1, s[44:47], s13 offen offset:3072 nt
  s_xor_b32 s13, s13, 0x40000
  s_barrier
  ds_read_b128 v[32:35], v28 offset:0
  ds_read_b128 v[36:39], v28 offset:16
  ds_read_b128 v[40:43], v28 offset:512
  ds_read_b128 v[44:47], v28 offset:528
  s_waitcnt lgkmcnt(0)
  v_add_f32 v32, v32, v40
  v_add_f32 v33, v33, v41
  v_add_f32 v34, v34, v42
  v_add_f32 v35, v35, v43
  v_add_f32 v36, v36, v44
  v_add_f32 v37, v37, v45
  v_add_f32 v38, v38, v46
  v_add_f32 v39, v39, v47
  v_cvt_pk_bf16_f32 v2, v32, v33
  v_cvt_pk_bf16_f32 v3, v34, v35
  v_cvt_pk_bf16_f32 v4, v36, v37
  v_cvt_pk_bf16_f32 v5, v38, v39
L_kloop:
  s_waitcnt vmcnt(9)
  v_subrev_u32 v53, s61, v52
  v_cmp_gt_u32 vcc, 64, v53
  s_add_u32 s60, s60, 1
  v_mov_b32 v53, s60
  s_bcnt1_i32_b32 s62, vcc_lo
  s_add_u32 s61, s60, 0
  global_load_dword v52, v54, s[58:59] sc0
  s_mov_b64 exec, 1
  global_store_dword v55, v53, s[58:59]
  s_mov_b64 exec, -1
  s_cmp_ge_u32 s62, 28
  s_cselect_b64 vcc, -1, 0
  s_cbranch_vccnz L_c29
  s_waitcnt vmcnt(6)
L_c29:
  s_waitcnt vmcnt(8)
  buffer_load_dwordx4 v[240:243], v1, s[44:47], s13 offen offset:0 nt
  v_dot2_f32_bf16 v18, v64, v2, 0
  v_dot2_f32_bf16 v19, v68, v2, 0
  v_dot2_f32_bf16 v20, v72, v2, 0
  v_dot2_f32_bf16 v21, v76, v2, 0
  s_cbranch_vccnz L_c30
  s_waitcnt vmcnt(6)
L_c30:
  s_waitcnt vmcnt(8)
  buffer_load_dwordx4 v[244:247], v1, s[44:47], s13 offen offset:1024 nt
  v_dot2c_f32_bf16 v18, v65, v3
  v_dot2c_f32_bf16 v19, v69, v3
  v_dot2c_f32_bf16 v20, v73, v3
  v_dot2c_f32_bf16 v21, v77, v3
  s_cbranch_vccnz L_c31
  s_waitcnt vmcnt(6)
L_c31:
  s_waitcnt vmcnt(8)
  buffer_load_dwordx4 v[248:251], v1, s[44:47], s13 offen offset:2048 nt
  v_dot2c_f32_bf16 v18, v66, v4
  v_dot2c_f32_bf16 v19, v70, v4
  v_dot2c_f32_bf16 v20, v74, v4
  v_dot2c_f32_bf16 v21, v78, v4
  s_cbranch_vccnz L_c32
  s_waitcnt vmcnt(6)
L_c32:
  s_waitcnt vmcnt(8)
  buffer_load_dwordx4 v[252:255], v1, s[44:47], s13 offen offset:3072 nt
  v_dot2c_f32_bf16 v18, v67, v5
  v_dot2c_f32_bf16 v19, v71, v5
  v_dot2c_f32_bf16 v20, v75, v5
  v_dot2c_f32_bf16 v21, v79, v5
  s_or_b32 s57, s57, 0xffe5ffff
  s_add_u32 s57, s57, 1
  s_and_b32 s57, s57, 0x1a0000
  s_xor_b32 s13, s56, s57
  s_nop 1
  v_add_f32_dpp v22, v18, v18 row_ror:8 row_mask:0xf bank_mask:0x3
  v_add_f32_dpp v23, v20, v20 row_ror:8 row_mask:0xf bank_mask:0x3
  v_add_f32_dpp v22, v19, v19 row_ror:8 row_mask:0xf bank_mask:0xc
  v_add_f32_dpp v23, v21, v21 row_ror:8 row_mask:0xf bank_mask:0xc
  s_nop 0
  v_add_f32_dpp v24, v22, v22 row_shl:4 row_mask:0xf bank_mask:0x5
  v_add_f32_dpp v24, v23, v23 row_shr:4 row_mask:0xf bank_mask:0xa
  s_cbranch_vccnz L_c33
  s_waitcnt vmcnt(6)
L_c33:
  s_waitcnt vmcnt(8)
  buffer_load_dwordx4 v[64:67], v1, s[44:47], s13 offen offset:0 nt
  v_dot2_f32_bf16 v18, v80, v2, 0
  v_dot2_f32_bf16 v19, v84, v2, 0
  v_dot2_f32_bf16 v20, v88, v2, 0
  v_dot2_f32_bf16 v21, v92, v2, 0
  s_cbranch_vccnz L_c34
  s_waitcnt vmcnt(4)
L_c34:
  s_waitcnt vmcnt(8)
  buffer_load_dwordx4 v[68:71], v1, s[44:47], s13 offen offset:1024 nt
  v_dot2c_f32_bf16 v18, v81, v3
  v_dot2c_f32_bf16 v19, v85, v3
  v_dot2c_f32_bf16 v20, v89, v3
  v_dot2c_f32_bf16 v21, v93, v3
  s_cbranch_vccnz L_c35
  s_waitcnt vmcnt(4)
L_c35:
  s_waitcnt vmcnt(8)
  buffer_load_dwordx4 v[72:75], v1, s[44:47], s13 offen offset:2048 nt
  v_dot2c_f32_bf16 v18, v82, v4
  v_dot2c_f32_bf16 v19, v86, v4
  v_dot2c_f32_bf16 v20, v90, v4
  v_dot2c_f32_bf16 v21, v94, v4
  s_cbranch_vccnz L_c36
  s_waitcnt vmcnt(4)
L_c36:
  s_waitcnt vmcnt(6)
  buffer_load_dwordx4 v[76:79], v1, s[44:47], s13 offen offset:3072 nt
  v_dot2c_f32_bf16 v18, v83, v5
  v_dot2c_f32_bf16 v19, v87, v5
  v_dot2c_f32_bf16 v20, v91, v5
  v_dot2c_f32_bf16 v21, v95, v5
  s_xor_b32 s13, s13, 0x40000
  s_nop 1
  v_add_f32_dpp v22, v18, v18 row_ror:8 row_mask:0xf bank_mask:0x3
  v_add_f32_dpp v23, v20, v20 row_ror:8 row_mask:0xf bank_mask:0x3
  v_add_f32_dpp v22, v19, v19 row_ror:8 row_mask:0xf bank_mask:0xc
  v_add_f32_dpp v23, v21, v21 row_ror:8 row_mask:0xf bank_mask:0xc
  s_nop 0
  v_add_f32_dpp v25, v22, v22 row_shl:4 row_mask:0xf bank_mask:0x5
  v_add_f32_dpp v25, v23, v23 row_shr:4 row_mask:0xf bank_mask:0xa
  s_waitcnt vmcnt(9)
  v_subrev_u32 v53, s61, v52
  v_cmp_gt_u32 vcc, 64, v53
  s_add_u32 s60, s60, 1
  v_mov_b32 v53, s60
  s_bcnt1_i32_b32 s62, vcc_lo
  s_add_u32 s61, s60, 0
  global_load_dword v52, v54, s[58:59] sc0
  s_mov_b64 exec, 1
  global_store_dword v55, v53, s[58:59]
  s_mov_b64 exec, -1
  s_cmp_ge_u32 s62, 28
  s_cselect_b64 vcc, -1, 0
  s_cbranch_vccnz L_c37
  s_waitcnt vmcnt(6)
L_c37:
  s_waitcnt vmcnt(8)
  buffer_load_dwordx4 v[80:83], v1, s[44:47], s13 offen offset:0 nt
  v_dot2_f32_bf16 v18, v96, v2, 0
  v_dot2_f32_bf16 v19, v100, v2, 0
  v_dot2_f32_bf16 v20, v104, v2, 0
  v_dot2_f32_bf16 v21, v108, v2, 0
  s_cbranch_vccnz L_c38
  s_waitcnt vmcnt(6)
L_c38:
  s_waitcnt vmcnt(8)
  buffer_load_dwordx4 v[84:87], v1, s[44:47], s13 offen offset:1024 nt
  v_dot2c_f32_bf16 v18, v97, v3
  v_dot2c_f32_bf16 v19, v101, v3
  v_dot2c_f32_bf16 v20, v105, v3
  v_dot2c_f32_bf16 v21, v109, v3
  s_cbranch_vccnz L_c39
  s_waitcnt vmcnt(6)
L_c39:
  s_waitcnt vmcnt(8)
  buffer_load_dwordx4 v[88:91], v1, s[44:47], s13 offen offset:2048 nt
  v_dot2c_f32_bf16 v18, v98, v4
  v_dot2c_f32_bf16 v19, v102, v4
  v_dot2c_f32_bf16 v20, v106, v4
  v_dot2c_f32_bf16 v21, v110, v4
  s_cbranch_vccnz L_c40
  s_waitcnt vmcnt(6)
L_c40:
  s_waitcnt vmcnt(8)
  buffer_load_dwordx4 v[92:95], v1, s[44:47], s13 offen offset:3072 nt
  v_dot2c_f32_bf16 v18, v99, v5
  v_dot2c_f32_bf16 v19, v103, v5
  v_dot2c_f32_bf16 v20, v107, v5
  v_dot2c_f32_bf16 v21, v111, v5
  s_xor_b32 s13, s13, 0x50000
  s_nop 1
  v_add_f32_dpp v22, v18, v18 row_ror:8 row_mask:0xf bank_mask:0x3
  v_add_f32_dpp v23, v20, v20 row_ror:8 row_mask:0xf bank_mask:0x3
  v_add_f32_dpp v22, v19, v19 row_ror:8 row_mask:0xf bank_mask:0xc
  v_add_f32_dpp v23, v21, v21 row_ror:8 row_mask:0xf bank_mask:0xc
  s_nop 0
  v_add_f32_dpp v26, v22, v22 row_shl:4 row_mask:0xf bank_mask:0x5
  v_add_f32_dpp v26, v23, v23 row_shr:4 row_mask:0xf bank_mask:0xa
  s_cbranch_vccnz L_c41
  s_waitcnt vmcnt(6)
L_c41:
  s_waitcnt vmcnt(8)
  buffer_load_dwordx4 v[96:99], v1, s[44:47], s13 offen offset:0 nt
  v_dot2_f32_bf16 v18, v112, v2, 0
  v_dot2_f32_bf16 v19, v116, v2, 0
  v_dot2_f32_bf16 v20, v120, v2, 0
  v_dot2_f32_bf16 v21, v124, v2, 0
  s_cbranch_vccnz L_c42
  s_waitcnt vmcnt(4)
L_c42:
  s_waitcnt vmcnt(8)
  buffer_load_dwordx4 v[100:103], v1, s[44:47], s13 offen offset:1024 nt
  v_dot2c_f32_bf16 v18, v113, v3
  v_dot2c_f32_bf16 v19, v117, v3
  v_dot2c_f32_bf16 v20, v121, v3
  v_dot2c_f32_bf16 v21, v125, v3
  s_cbranch_vccnz L_c43
  s_waitcnt vmcnt(4)
L_c43:
  s_waitcnt vmcnt(8)
  buffer_load_dwordx4 v[104:107], v1, s[44:47], s13 offen offset:2048 nt
  v_dot2c_f32_bf16 v18, v114, v4
  v_dot2c_f32_bf16 v19, v118, v4
  v_dot2c_f32_bf16 v20, v122, v4
  v_dot2c_f32_bf16 v21, v126, v4
  s_cbranch_vccnz L_c44
  s_waitcnt vmcnt(4)
L_c44:
  s_waitcnt vmcnt(6)
  buffer_load_dwordx4 v[108:111], v1, s[44:47], s13 offen offset:3072 nt
  v_dot2c_f32_bf16 v18, v115, v5
  v_dot2c_f32_bf16 v19, v119, v5
  v_dot2c_f32_bf16 v20, v123, v5
  v_dot2c_f32_bf16 v21, v127, v5
  s_xor_b32 s13, s13, 0x40000
  s_nop 1
  v_add_f32_dpp v22, v18, v18 row_ror:8 row_mask:0xf bank_mask:0x3
  v_add_f32_dpp v23, v20, v20 row_ror:8 row_mask:0xf bank_mask:0x3
  v_add_f32_dpp v22, v19, v19 row_ror:8 row_mask:0xf bank_mask:0xc
  v_add_f32_dpp v23, v21, v21 row_ror:8 row_mask:0xf bank_mask:0xc
  s_nop 0
  v_add_f32_dpp v27, v22, v22 row_shl:4 row_mask:0xf bank_mask:0x5
  v_add_f32_dpp v27, v23, v23 row_shr:4 row_mask:0xf bank_mask:0xa
  v_mov_b32 v10, v11
  v_mov_b32 v11, v12
  v_mov_b32 v12, v13
  v_mov_b32 v13, v14
  v_mov_b32 v14, v15
  v_mov_b32 v15, v16
  v_mov_b32 v16, v17
  v_add_f32_dpp v24, v24, v24 quad_perm:[2,3,0,1] row_mask:0xf bank_mask:0xf
  v_add_f32_dpp v25, v25, v25 quad_perm:[2,3,0,1] row_mask:0xf bank_mask:0xf
  v_add_f32_dpp v26, v26, v26 quad_perm:[2,3,0,1] row_mask:0xf bank_mask:0xf
  v_add_f32_dpp v27, v27, v27 quad_perm:[2,3,0,1] row_mask:0xf bank_mask:0xf
  v_cndmask_b32 v24, v24, v25, s[50:51]
  v_cndmask_b32 v26, v26, v27, s[50:51]
  s_add_u32 s14, s14, 1
  v_add_f32_dpp v24, v24, v24 quad_perm:[1,0,3,2] row_mask:0xf bank_mask:0xf
  v_add_f32_dpp v26, v26, v26 quad_perm:[1,0,3,2] row_mask:0xf bank_mask:0xf
  v_cndmask_b32 v17, v24, v26, s[52:53]
  s_waitcnt vmcnt(9)
  v_subrev_u32 v53, s61, v52
  v_cmp_gt_u32 vcc, 64, v53
  s_add_u32 s60, s60, 1
  v_mov_b32 v53, s60
  s_bcnt1_i32_b32 s62, vcc_lo
  s_add_u32 s61, s60, 0
  global_load_dword v52, v54, s[58:59] sc0
  s_mov_b64 exec, 1
  global_store_dword v55, v53, s[58:59]
  s_mov_b64 exec, -1
  s_cmp_ge_u32 s62, 28
  s_cselect_b64 vcc, -1, 0
  s_cbranch_vccnz L_c45
  s_waitcnt vmcnt(6)
L_c45:
  s_waitcnt vmcnt(8)
  buffer_load_dwordx4 v[112:115], v1, s[44:47], s13 offen offset:0 nt
  v_dot2_f32_bf16 v18, v128, v2, 0
  v_dot2_f32_bf16 v19, v132, v2, 0
  v_dot2_f32_bf16 v20, v136, v2, 0
  v_dot2_f32_bf16 v21, v140, v2, 0
  s_cbranch_vccnz L_c46
  s_waitcnt vmcnt(6)
L_c46:
  s_waitcnt vmcnt(8)
  buffer_load_dwordx4 v[116:119], v1, s[44:47], s13 offen offset:1024 nt
  v_dot2c_f32_bf16 v18, v129, v3
  v_dot2c_f32_bf16 v19, v133, v3
  v_dot2c_f32_bf16 v20, v137, v3
  v_dot2c_f32_bf16 v21, v141, v3
  s_cbranch_vccnz L_c47
  s_waitcnt vmcnt(6)
L_c47:
  s_waitcnt vmcnt(8)
  buffer_load_dwordx4 v[120:123], v1, s[44:47], s13 offen offset:2048 nt
  v_dot2c_f32_bf16 v18, v130, v4
  v_dot2c_f32_bf16 v19, v134, v4
  v_dot2c_f32_bf16 v20, v138, v4
  v_dot2c_f32_bf16 v21, v142, v4
  s_cbranch_vccnz L_c48
  s_waitcnt vmcnt(6)
L_c48:
  s_waitcnt vmcnt(8)
  buffer_load_dwordx4 v[124:127], v1, s[44:47], s13 offen offset:3072 nt
  v_dot2c_f32_bf16 v18, v131, v5
  v_dot2c_f32_bf16 v19, v135, v5
  v_dot2c_f32_bf16 v20, v139, v5
  v_dot2c_f32_bf16 v21, v143, v5
  s_or_b32 s57, s57, 0xffe5ffff
  s_add_u32 s57, s57, 1
  s_and_b32 s57, s57, 0x1a0000
  s_xor_b32 s13, s56, s57
  s_nop 1
  v_add_f32_dpp v22, v18, v18 row_ror:8 row_mask:0xf bank_mask:0x3
  v_add_f32_dpp v23, v20, v20 row_ror:8 row_mask:0xf bank_mask:0x3
  v_add_f32_dpp v22, v19, v19 row_ror:8 row_mask:0xf bank_mask:0xc
  v_add_f32_dpp v23, v21, v21 row_ror:8 row_mask:0xf bank_mask:0xc
  s_nop 0
  v_add_f32_dpp v24, v22, v22 row_shl:4 row_mask:0xf bank_mask:0x5
  v_add_f32_dpp v24, v23, v23 row_shr:4 row_mask:0xf bank_mask:0xa
  s_cbranch_vccnz L_c49
  s_waitcnt vmcnt(6)
L_c49:
  s_waitcnt vmcnt(8)
  buffer_load_dwordx4 v[128:131], v1, s[44:47], s13 offen offset:0 nt
  v_dot2_f32_bf16 v18, v144, v2, 0
  v_dot2_f32_bf16 v19, v148, v2, 0
  v_dot2_f32_bf16 v20, v152, v2, 0
  v_dot2_f32_bf16 v21, v156, v2, 0
  s_cbranch_vccnz L_c50
  s_waitcnt vmcnt(4)
L_c50:
  s_waitcnt vmcnt(8)
  buffer_load_dwordx4 v[132:135], v1, s[44:47], s13 offen offset:1024 nt
  v_dot2c_f32_bf16 v18, v145, v3
  v_dot2c_f32_bf16 v19, v149, v3
  v_dot2c_f32_bf16 v20, v153, v3
  v_dot2c_f32_bf16 v21, v157, v3
  s_cbranch_vccnz L_c51
  s_waitcnt vmcnt(4)
L_c51:
  s_waitcnt vmcnt(8)
  buffer_load_dwordx4 v[136:139], v1, s[44:47], s13 offen offset:2048 nt
  v_dot2c_f32_bf16 v18, v146, v4
  v_dot2c_f32_bf16 v19, v150, v4
  v_dot2c_f32_bf16 v20, v154, v4
  v_dot2c_f32_bf16 v21, v158, v4
  s_cbranch_vccnz L_c52
  s_waitcnt vmcnt(4)
L_c52:
  s_waitcnt vmcnt(6)
  buffer_load_dwordx4 v[140:143], v1, s[44:47], s13 offen offset:3072 nt
  v_dot2c_f32_bf16 v18, v147, v5
  v_dot2c_f32_bf16 v19, v151, v5
  v_dot2c_f32_bf16 v20, v155, v5
  v_dot2c_f32_bf16 v21, v159, v5
  s_xor_b32 s13, s13, 0x40000
  s_nop 1
  v_add_f32_dpp v22, v18, v18 row_ror:8 row_mask:0xf bank_mask:0x3
  v_add_f32_dpp v23, v20, v20 row_ror:8 row_mask:0xf bank_mask:0x3
  v_add_f32_dpp v22, v19, v19 row_ror:8 row_mask:0xf bank_mask:0xc
  v_add_f32_dpp v23, v21, v21 row_ror:8 row_mask:0xf bank_mask:0xc
  s_nop 0
  v_add_f32_dpp v25, v22, v22 row_shl:4 row_mask:0xf bank_mask:0x5
  v_add_f32_dpp v25, v23, v23 row_shr:4 row_mask:0xf bank_mask:0xa
  s_waitcnt vmcnt(9)
  v_subrev_u32 v53, s61, v52
  v_cmp_gt_u32 vcc, 64, v53
  s_add_u32 s60, s60, 1
  v_mov_b32 v53, s60
  s_bcnt1_i32_b32 s62, vcc_lo
  s_add_u32 s61, s60, 0
  global_load_dword v52, v54, s[58:59] sc0
  s_mov_b64 exec, 1
  global_store_dword v55, v53, s[58:59]
  s_mov_b64 exec, -1
  s_cmp_ge_u32 s62, 28
  s_cselect_b64 vcc, -1, 0
  s_cbranch_vccnz L_c53
  s_waitcnt vmcnt(6)
L_c53:
  s_waitcnt vmcnt(8)
  buffer_load_dwordx4 v[144:147], v1, s[44:47], s13 offen offset:0 nt
  v_dot2_f32_bf16 v18, v160, v2, 0
  v_dot2_f32_bf16 v19, v164, v2, 0
  v_dot2_f32_bf16 v20, v168, v2, 0
  v_dot2_f32_bf16 v21, v172, v2, 0
  s_cbranch_vccnz L_c54
  s_waitcnt vmcnt(6)
L_c54:
  s_waitcnt vmcnt(8)
  buffer_load_dwordx4 v[148:151], v1, s[44:47], s13 offen offset:1024 nt
  v_dot2c_f32_bf16 v18, v161, v3
  v_dot2c_f32_bf16 v19, v165, v3
  v_dot2c_f32_bf16 v20, v169, v3
  v_dot2c_f32_bf16 v21, v173, v3
  s_cbranch_vccnz L_c55
  s_waitcnt vmcnt(6)
L_c55:
  s_waitcnt vmcnt(8)
  buffer_load_dwordx4 v[152:155], v1, s[44:47], s13 offen offset:2048 nt
  v_dot2c_f32_bf16 v18, v162, v4
  v_dot2c_f32_bf16 v19, v166, v4
  v_dot2c_f32_bf16 v20, v170, v4
  v_dot2c_f32_bf16 v21, v174, v4
  s_cbranch_vccnz L_c56
  s_waitcnt vmcnt(6)
L_c56:
  s_waitcnt vmcnt(8)
  buffer_load_dwordx4 v[156:159], v1, s[44:47], s13 offen offset:3072 nt
  v_dot2c_f32_bf16 v18, v163, v5
  v_dot2c_f32_bf16 v19, v167, v5
  v_dot2c_f32_bf16 v20, v171, v5
  v_dot2c_f32_bf16 v21, v175, v5
  s_xor_b32 s13, s13, 0x50000
  s_nop 1
  v_add_f32_dpp v22, v18, v18 row_ror:8 row_mask:0xf bank_mask:0x3
  v_add_f32_dpp v23, v20, v20 row_ror:8 row_mask:0xf bank_mask:0x3
  v_add_f32_dpp v22, v19, v19 row_ror:8 row_mask:0xf bank_mask:0xc
  v_add_f32_dpp v23, v21, v21 row_ror:8 row_mask:0xf bank_mask:0xc
  s_nop 0
  v_add_f32_dpp v26, v22, v22 row_shl:4 row_mask:0xf bank_mask:0x5
  v_add_f32_dpp v26, v23, v23 row_shr:4 row_mask:0xf bank_mask:0xa
  s_cbranch_vccnz L_c57
  s_waitcnt vmcnt(6)
L_c57:
  s_waitcnt vmcnt(8)
  buffer_load_dwordx4 v[160:163], v1, s[44:47], s13 offen offset:0 nt
  v_dot2_f32_bf16 v18, v176, v2, 0
  v_dot2_f32_bf16 v19, v180, v2, 0
  v_dot2_f32_bf16 v20, v184, v2, 0
  v_dot2_f32_bf16 v21, v188, v2, 0
  s_cbranch_vccnz L_c58
  s_waitcnt vmcnt(4)
L_c58:
  s_waitcnt vmcnt(8)
  buffer_load_dwordx4 v[164:167], v1, s[44:47], s13 offen offset:1024 nt
  v_dot2c_f32_bf16 v18, v177, v3
  v_dot2c_f32_bf16 v19, v181, v3
  v_dot2c_f32_bf16 v20, v185, v3
  v_dot2c_f32_bf16 v21, v189, v3
  s_cbranch_vccnz L_c59
  s_waitcnt vmcnt(4)
L_c59:
  s_waitcnt vmcnt(8)
  buffer_load_dwordx4 v[168:171], v1, s[44:47], s13 offen offset:2048 nt
  v_dot2c_f32_bf16 v18, v178, v4
  v_dot2c_f32_bf16 v19, v182, v4
  v_dot2c_f32_bf16 v20, v186, v4
  v_dot2c_f32_bf16 v21, v190, v4
  s_cbranch_vccnz L_c60
  s_waitcnt vmcnt(4)
L_c60:
  s_waitcnt vmcnt(6)
  buffer_load_dwordx4 v[172:175], v1, s[44:47], s13 offen offset:3072 nt
  v_dot2c_f32_bf16 v18, v179, v5
  v_dot2c_f32_bf16 v19, v183, v5
  v_dot2c_f32_bf16 v20, v187, v5
  v_dot2c_f32_bf16 v21, v191, v5
  s_xor_b32 s13, s13, 0x40000
  s_nop 1
  v_add_f32_dpp v22, v18, v18 row_ror:8 row_mask:0xf bank_mask:0x3
  v_add_f32_dpp v23, v20, v20 row_ror:8 row_mask:0xf bank_mask:0x3
  v_add_f32_dpp v22, v19, v19 row_ror:8 row_mask:0xf bank_mask:0xc
  v_add_f32_dpp v23, v21, v21 row_ror:8 row_mask:0xf bank_mask:0xc
  s_nop 0
  v_add_f32_dpp v27, v22, v22 row_shl:4 row_mask:0xf bank_mask:0x5
  v_add_f32_dpp v27, v23, v23 row_shr:4 row_mask:0xf bank_mask:0xa
  v_mov_b32 v10, v11
  v_mov_b32 v11, v12
  v_mov_b32 v12, v13
  v_mov_b32 v13, v14
  v_mov_b32 v14, v15
  v_mov_b32 v15, v16
  v_mov_b32 v16, v17
  v_add_f32_dpp v24, v24, v24 quad_perm:[2,3,0,1] row_mask:0xf bank_mask:0xf
  v_add_f32_dpp v25, v25, v25 quad_perm:[2,3,0,1] row_mask:0xf bank_mask:0xf
  v_add_f32_dpp v26, v26, v26 quad_perm:[2,3,0,1] row_mask:0xf bank_mask:0xf
  v_add_f32_dpp v27, v27, v27 quad_perm:[2,3,0,1] row_mask:0xf bank_mask:0xf
  v_cndmask_b32 v24, v24, v25, s[50:51]
  v_cndmask_b32 v26, v26, v27, s[50:51]
  s_add_u32 s14, s14, 1
  v_add_f32_dpp v24, v24, v24 quad_perm:[1,0,3,2] row_mask:0xf bank_mask:0xf
  v_add_f32_dpp v26, v26, v26 quad_perm:[1,0,3,2] row_mask:0xf bank_mask:0xf
  v_cndmask_b32 v17, v24, v26, s[52:53]
  s_cmp_eq_u32 s14, 11
  s_cbranch_scc1 L_soft
  s_waitcnt vmcnt(9)
  v_subrev_u32 v53, s61, v52
  v_cmp_gt_u32 vcc, 64, v53
  s_add_u32 s60, s60, 1
  v_mov_b32 v53, s60
  s_bcnt1_i32_b32 s62, vcc_lo
  s_add_u32 s61, s60, 0
  global_load_dword v52, v54, s[58:59] sc0
  s_mov_b64 exec, 1
  global_store_dword v55, v53, s[58:59]
  s_mov_b64 exec, -1
  s_cmp_ge_u32 s62, 28
  s_cselect_b64 vcc, -1, 0
  s_cbranch_vccnz L_c61
  s_waitcnt vmcnt(6)
L_c61:
  s_waitcnt vmcnt(8)
  buffer_load_dwordx4 v[176:179], v1, s[44:47], s13 offen offset:0 nt
  v_dot2_f32_bf16 v18, v192, v2, 0
  v_dot2_f32_bf16 v19, v196, v2, 0
  v_dot2_f32_bf16 v20, v200, v2, 0
  v_dot2_f32_bf16 v21, v204, v2, 0
  s_cbranch_vccnz L_c62
  s_waitcnt vmcnt(6)
L_c62:
  s_waitcnt vmcnt(8)
  buffer_load_dwordx4 v[180:183], v1, s[44:47], s13 offen offset:1024 nt
  v_dot2c_f32_bf16 v18, v193, v3
  v_dot2c_f32_bf16 v19, v197, v3
  v_dot2c_f32_bf16 v20, v201, v3
  v_dot2c_f32_bf16 v21, v205, v3
  s_cbranch_vccnz L_c63
  s_waitcnt vmcnt(6)
L_c63:
  s_waitcnt vmcnt(8)
  buffer_load_dwordx4 v[184:187], v1, s[44:47], s13 offen offset:2048 nt
  v_dot2c_f32_bf16 v18, v194, v4
  v_dot2c_f32_bf16 v19, v198, v4
  v_dot2c_f32_bf16 v20, v202, v4
  v_dot2c_f32_bf16 v21, v206, v4
  s_cbranch_vccnz L_c64
  s_waitcnt vmcnt(6)
L_c64:
  s_waitcnt vmcnt(8)
  buffer_load_dwordx4 v[188:191], v1, s[44:47], s13 offen offset:3072 nt
  v_dot2c_f32_bf16 v18, v195, v5
  v_dot2c_f32_bf16 v19, v199, v5
  v_dot2c_f32_bf16 v20, v203, v5
  v_dot2c_f32_bf16 v21, v207, v5
  s_or_b32 s57, s57, 0xffe5ffff
  s_add_u32 s57, s57, 1
  s_and_b32 s57, s57, 0x1a0000
  s_xor_b32 s13, s56, s57
  s_nop 1
  v_add_f32_dpp v22, v18, v18 row_ror:8 row_mask:0xf bank_mask:0x3
  v_add_f32_dpp v23, v20, v20 row_ror:8 row_mask:0xf bank_mask:0x3
  v_add_f32_dpp v22, v19, v19 row_ror:8 row_mask:0xf bank_mask:0xc
  v_add_f32_dpp v23, v21, v21 row_ror:8 row_mask:0xf bank_mask:0xc
  s_nop 0
  v_add_f32_dpp v24, v22, v22 row_shl:4 row_mask:0xf bank_mask:0x5
  v_add_f32_dpp v24, v23, v23 row_shr:4 row_mask:0xf bank_mask:0xa
  s_cmp_eq_u32 s14, 8
  s_cselect_b32 s44, s48, s44
  s_cselect_b32 s45, s49, s45
  s_cbranch_vccnz L_c65
  s_waitcnt vmcnt(6)
L_c65:
  s_waitcnt vmcnt(8)
  buffer_load_dwordx4 v[192:195], v1, s[44:47], s13 offen offset:0 nt
  v_dot2_f32_bf16 v18, v208, v2, 0
  v_dot2_f32_bf16 v19, v212, v2, 0
  v_dot2_f32_bf16 v20, v216, v2, 0
  v_dot2_f32_bf16 v21, v220, v2, 0
  s_cbranch_vccnz L_c66
  s_waitcnt vmcnt(4)
L_c66:
  s_waitcnt vmcnt(8)
  buffer_load_dwordx4 v[196:199], v1, s[44:47], s13 offen offset:1024 nt
  v_dot2c_f32_bf16 v18, v209, v3
  v_dot2c_f32_bf16 v19, v213, v3
  v_dot2c_f32_bf16 v20, v217, v3
  v_dot2c_f32_bf16 v21, v221, v3
  s_cbranch_vccnz L_c67
  s_waitcnt vmcnt(4)
L_c67:
  s_waitcnt vmcnt(8)
  buffer_load_dwordx4 v[200:203], v1, s[44:47], s13 offen offset:2048 nt
  v_dot2c_f32_bf16 v18, v210, v4
  v_dot2c_f32_bf16 v19, v214, v4
  v_dot2c_f32_bf16 v20, v218, v4
  v_dot2c_f32_bf16 v21, v222, v4
  s_cbranch_vccnz L_c68
  s_waitcnt vmcnt(4)
L_c68:
  s_waitcnt vmcnt(6)
  buffer_load_dwordx4 v[204:207], v1, s[44:47], s13 offen offset:3072 nt
  v_dot2c_f32_bf16 v18, v211, v5
  v_dot2c_f32_bf16 v19, v215, v5
  v_dot2c_f32_bf16 v20, v219, v5
  v_dot2c_f32_bf16 v21, v223, v5
  s_xor_b32 s13, s13, 0x40000
  s_nop 1
  v_add_f32_dpp v22, v18, v18 row_ror:8 row_mask:0xf bank_mask:0x3
  v_add_f32_dpp v23, v20, v20 row_ror:8 row_mask:0xf bank_mask:0x3
  v_add_f32_dpp v22, v19, v19 row_ror:8 row_mask:0xf bank_mask:0xc
  v_add_f32_dpp v23, v21, v21 row_ror:8 row_mask:0xf bank_mask:0xc
  s_nop 0
  v_add_f32_dpp v25, v22, v22 row_shl:4 row_mask:0xf bank_mask:0x5
  v_add_f32_dpp v25, v23, v23 row_shr:4 row_mask:0xf bank_mask:0xa
  s_waitcnt vmcnt(9)
  v_subrev_u32 v53, s61, v52
  v_cmp_gt_u32 vcc, 64, v53
  s_add_u32 s60, s60, 1
  v_mov_b32 v53, s60
  s_bcnt1_i32_b32 s62, vcc_lo
  s_add_u32 s61, s60, 0
  global_load_dword v52, v54, s[58:59] sc0
  s_mov_b64 exec, 1
  global_store_dword v55, v53, s[58:59]
  s_mov_b64 exec, -1
  s_cmp_ge_u32 s62, 28
  s_cselect_b64 vcc, -1, 0
  s_cbranch_vccnz L_c69
  s_waitcnt vmcnt(6)
L_c69:
  s_waitcnt vmcnt(8)
  buffer_load_dwordx4 v[208:211], v1, s[44:47], s13 offen offset:0 nt
  v_dot2_f32_bf16 v18, v224, v2, 0
  v_dot2_f32_bf16 v19, v228, v2, 0
  v_dot2_f32_bf16 v20, v232, v2, 0
  v_dot2_f32_bf16 v21, v236, v2, 0
  s_cbranch_vccnz L_c70
  s_waitcnt vmcnt(6)
L_c70:
  s_waitcnt vmcnt(8)
  buffer_load_dwordx4 v[212:215], v1, s[44:47], s13 offen offset:1024 nt
  v_dot2c_f32_bf16 v18, v225, v3
  v_dot2c_f32_bf16 v19, v229, v3
  v_dot2c_f32_bf16 v20, v233, v3
  v_dot2c_f32_bf16 v21, v237, v3
  s_cbranch_vccnz L_c71
  s_waitcnt vmcnt(6)
L_c71:
  s_waitcnt vmcnt(8)
  buffer_load_dwordx4 v[216:219], v1, s[44:47], s13 offen offset:2048 nt
  v_dot2c_f32_bf16 v18, v226, v4
  v_dot2c_f32_bf16 v19, v230, v4
  v_dot2c_f32_bf16 v20, v234, v4
  v_dot2c_f32_bf16 v21, v238, v4
  s_cbranch_vccnz L_c72
  s_waitcnt vmcnt(6)
L_c72:
  s_waitcnt vmcnt(8)
  buffer_load_dwordx4 v[220:223], v1, s[44:47], s13 offen offset:3072 nt
  v_dot2c_f32_bf16 v18, v227, v5
  v_dot2c_f32_bf16 v19, v231, v5
  v_dot2c_f32_bf16 v20, v235, v5
  v_dot2c_f32_bf16 v21, v239, v5
  s_xor_b32 s13, s13, 0x50000
  s_nop 1
  v_add_f32_dpp v22, v18, v18 row_ror:8 row_mask:0xf bank_mask:0x3
  v_add_f32_dpp v23, v20, v20 row_ror:8 row_mask:0xf bank_mask:0x3
  v_add_f32_dpp v22, v19, v19 row_ror:8 row_mask:0xf bank_mask:0xc
  v_add_f32_dpp v23, v21, v21 row_ror:8 row_mask:0xf bank_mask:0xc
  s_nop 0
  v_add_f32_dpp v26, v22, v22 row_shl:4 row_mask:0xf bank_mask:0x5
  v_add_f32_dpp v26, v23, v23 row_shr:4 row_mask:0xf bank_mask:0xa
  s_cbranch_vccnz L_c73
  s_waitcnt vmcnt(6)
L_c73:
  s_waitcnt vmcnt(8)
  buffer_load_dwordx4 v[224:227], v1, s[44:47], s13 offen offset:0 nt
  v_dot2_f32_bf16 v18, v240, v2, 0
  v_dot2_f32_bf16 v19, v244, v2, 0
  v_dot2_f32_bf16 v20, v248, v2, 0
  v_dot2_f32_bf16 v21, v252, v2, 0
  s_cbranch_vccnz L_c74
  s_waitcnt vmcnt(4)
L_c74:
  s_waitcnt vmcnt(8)
  buffer_load_dwordx4 v[228:231], v1, s[44:47], s13 offen offset:1024 nt
  v_dot2c_f32_bf16 v18, v241, v3
  v_dot2c_f32_bf16 v19, v245, v3
  v_dot2c_f32_bf16 v20, v249, v3
  v_dot2c_f32_bf16 v21, v253, v3
  s_cbranch_vccnz L_c75
  s_waitcnt vmcnt(4)
L_c75:
  s_waitcnt vmcnt(8)
  buffer_load_dwordx4 v[232:235], v1, s[44:47], s13 offen offset:2048 nt
  v_dot2c_f32_bf16 v18, v242, v4
  v_dot2c_f32_bf16 v19, v246, v4
  v_dot2c_f32_bf16 v20, v250, v4
  v_dot2c_f32_bf16 v21, v254, v4
  s_cbranch_vccnz L_c76
  s_waitcnt vmcnt(4)
L_c76:
  s_waitcnt vmcnt(6)
  buffer_load_dwordx4 v[236:239], v1, s[44:47], s13 offen offset:3072 nt
  v_dot2c_f32_bf16 v18, v243, v5
  v_dot2c_f32_bf16 v19, v247, v5
  v_dot2c_f32_bf16 v20, v251, v5
  v_dot2c_f32_bf16 v21, v255, v5
  s_xor_b32 s13, s13, 0x40000
  s_nop 1
  v_add_f32_dpp v22, v18, v18 row_ror:8 row_mask:0xf bank_mask:0x3
  v_add_f32_dpp v23, v20, v20 row_ror:8 row_mask:0xf bank_mask:0x3
  v_add_f32_dpp v22, v19, v19 row_ror:8 row_mask:0xf bank_mask:0xc
  v_add_f32_dpp v23, v21, v21 row_ror:8 row_mask:0xf bank_mask:0xc
  s_nop 0
  v_add_f32_dpp v27, v22, v22 row_shl:4 row_mask:0xf bank_mask:0x5
  v_add_f32_dpp v27, v23, v23 row_shr:4 row_mask:0xf bank_mask:0xa
  v_mov_b32 v10, v11
  v_mov_b32 v11, v12
  v_mov_b32 v12, v13
  v_mov_b32 v13, v14
  v_mov_b32 v14, v15
  v_mov_b32 v15, v16
  v_mov_b32 v16, v17
  v_add_f32_dpp v24, v24, v24 quad_perm:[2,3,0,1] row_mask:0xf bank_mask:0xf
  v_add_f32_dpp v25, v25, v25 quad_perm:[2,3,0,1] row_mask:0xf bank_mask:0xf
  v_add_f32_dpp v26, v26, v26 quad_perm:[2,3,0,1] row_mask:0xf bank_mask:0xf
  v_add_f32_dpp v27, v27, v27 quad_perm:[2,3,0,1] row_mask:0xf bank_mask:0xf
  v_cndmask_b32 v24, v24, v25, s[50:51]
  v_cndmask_b32 v26, v26, v27, s[50:51]
  s_add_u32 s14, s14, 1
  v_add_f32_dpp v24, v24, v24 quad_perm:[1,0,3,2] row_mask:0xf bank_mask:0xf
  v_add_f32_dpp v26, v26, v26 quad_perm:[1,0,3,2] row_mask:0xf bank_mask:0xf
  v_cndmask_b32 v17, v24, v26, s[52:53]
  s_branch L_kloop
L_soft:
  s_cbranch_vccnz L_c77
  s_waitcnt vmcnt(4)
L_c77:
  s_waitcnt vmcnt(6)
  buffer_load_dwordx4 v[176:179], v1, s[44:47], s13 offen offset:0 nt
  s_mov_b32 s54, 0x3db504f3
  s_mov_b32 s55, 0x3fb8aa3b
  v_cvt_pk_bf16_f32 v10, 0, v10
  v_cvt_pk_bf16_f32 v11, 0, v11
  v_cvt_pk_bf16_f32 v12, 0, v12
  v_cvt_pk_bf16_f32 v13, 0, v13
  v_cvt_pk_bf16_f32 v14, 0, v14
  v_cvt_pk_bf16_f32 v15, 0, v15
  v_cvt_pk_bf16_f32 v16, 0, v16
  v_cvt_pk_bf16_f32 v17, 0, v17
  v_mul_f32 v10, s54, v10
  v_mul_f32 v11, s54, v11
  v_mul_f32 v12, s54, v12
  v_mul_f32 v13, s54, v13
  v_mul_f32 v14, s54, v14
  v_mul_f32 v15, s54, v15
  v_mul_f32 v16, s54, v16
  v_mul_f32 v17, s54, v17
  v_cvt_pk_bf16_f32 v10, 0, v10
  v_cvt_pk_bf16_f32 v11, 0, v11
  v_cvt_pk_bf16_f32 v12, 0, v12
  v_cvt_pk_bf16_f32 v13, 0, v13
  v_cvt_pk_bf16_f32 v14, 0, v14
  v_cvt_pk_bf16_f32 v15, 0, v15
  v_cvt_pk_bf16_f32 v16, 0, v16
  v_cvt_pk_bf16_f32 v17, 0, v17
  v_mul_f32 v10, s55, v10
  v_mul_f32 v11, s55, v11
  v_mul_f32 v12, s55, v12
  v_mul_f32 v13, s55, v13
  v_mul_f32 v14, s55, v14
  v_mul_f32 v15, s55, v15
  v_mul_f32 v16, s55, v16
  v_mul_f32 v17, s55, v17
  v_max3_f32 v18, v10, v11, v12
  v_max3_f32 v19, v13, v14, v15
  v_max3_f32 v18, v18, v16, v17
  v_max_f32 v18, v18, v19
  s_cbranch_vccnz L_c78
  s_waitcnt vmcnt(4)
L_c78:
  s_waitcnt vmcnt(6)
  buffer_load_dwordx4 v[180:183], v1, s[44:47], s13 offen offset:1024 nt
  s_nop 1
  v_max_f32_dpp v18, v18, v18 row_ror:8 row_mask:0xf bank_mask:0xf
  s_nop 1
  v_max_f32_dpp v18, v18, v18 row_ror:4 row_mask:0xf bank_mask:0xf
  s_nop 1
  v_max_f32_dpp v18, v18, v18 row_ror:2 row_mask:0xf bank_mask:0xf
  s_nop 1
  v_max_f32_dpp v18, v18, v18 row_ror:1 row_mask:0xf bank_mask:0xf
  s_nop 1
  v_mov_b32 v20, v18
  s_nop 1
  v_permlane16_swap_b32 v18, v20
  s_nop 1
  v_max_f32 v18, v18, v20
  v_mov_b32 v20, v18
  s_nop 1
  v_permlane32_swap_b32 v18, v20
  s_nop 1
  v_max_f32 v18, v18, v20
  v_sub_f32 v10, v10, v18
  v_sub_f32 v11, v11, v18
  v_sub_f32 v12, v12, v18
  v_sub_f32 v13, v13, v18
  v_sub_f32 v14, v14, v18
  v_sub_f32 v15, v15, v18
  v_sub_f32 v16, v16, v18
  v_sub_f32 v17, v17, v18
  v_exp_f32 v10, v10
  v_exp_f32 v11, v11
  v_exp_f32 v12, v12
  v_exp_f32 v13, v13
  v_exp_f32 v14, v14
  v_exp_f32 v15, v15
  v_exp_f32 v16, v16
  v_exp_f32 v17, v17
  s_cbranch_vccnz L_c79
  s_waitcnt vmcnt(4)
L_c79:
  s_waitcnt vmcnt(6)
  buffer_load_dwordx4 v[184:187], v1, s[44:47], s13 offen offset:2048 nt
  v_add_f32 v19, v10, v11
  v_add_f32 v20, v12, v13
  v_add_f32 v21, v14, v15
  v_add_f32 v22, v16, v17
  v_add_f32 v19, v19, v20
  v_add_f32 v21, v21, v22
  v_add_f32 v19, v19, v21
  s_nop 1
  v_add_f32_dpp v19, v19, v19 row_ror:8 row_mask:0xf bank_mask:0xf
  s_nop 1
  v_add_f32_dpp v19, v19, v19 row_ror:4 row_mask:0xf bank_mask:0xf
  s_nop 1
  v_add_f32_dpp v19, v19, v19 row_ror:2 row_mask:0xf bank_mask:0xf
  s_nop 1
  v_add_f32_dpp v19, v19, v19 row_ror:1 row_mask:0xf bank_mask:0xf
  s_nop 1
  v_mov_b32 v20, v19
  s_nop 1
  v_permlane16_swap_b32 v19, v20
  s_nop 1
  v_add_f32 v19, v19, v20
  v_mov_b32 v20, v19
  s_nop 1
  v_permlane32_swap_b32 v19, v20
  s_nop 1
  v_add_f32 v19, v19, v20
  v_cvt_pk_bf16_f32 v10, v10, v10
  v_cvt_pk_bf16_f32 v11, v11, v11
  v_cvt_pk_bf16_f32 v12, v12, v12
  v_cvt_pk_bf16_f32 v13, v13, v13
  v_cvt_pk_bf16_f32 v14, v14, v14
  v_cvt_pk_bf16_f32 v15, v15, v15
  v_cvt_pk_bf16_f32 v16, v16, v16
  v_cvt_pk_bf16_f32 v17, v17, v17
  s_lshl_b32 s15, s10, 3
  v_mov_b32 v20, s15
  ds_write_b64 v20, v[18:19] offset:1024
  v_mov_b32 v32, 0
  v_mov_b32 v33, 0
  v_mov_b32 v34, 0
  v_mov_b32 v35, 0
  v_and_b32 v29, 16, v0
  v_add_u32 v28, v28, v29
  s_lshl_b32 s15, s10, 9
  v_add_u32 v28, s15, v28
  s_cbranch_vccnz L_c80
  s_waitcnt vmcnt(4)
L_c80:
  s_waitcnt vmcnt(6)
  buffer_load_dwordx4 v[188:191], v1, s[44:47], s13 offen offset:3072 nt
  s_or_b32 s57, s57, 0xffe5ffff
  s_add_u32 s57, s57, 1
  s_and_b32 s57, s57, 0x1a0000
  s_xor_b32 s13, s56, s57
  s_waitcnt lgkmcnt(0)
  s_barrier
  s_branch L_v2
L_vloop:
  v_mov_b32 v10, v11
  v_mov_b32 v11, v12
  v_mov_b32 v12, v13
  v_mov_b32 v13, v14
  v_mov_b32 v14, v15
  v_mov_b32 v15, v16
  v_mov_b32 v16, v17
  v_and_b32_dpp v36, v10, v6 row_newbcast:0 row_mask:0xf bank_mask:0xf
  v_and_b32_dpp v37, v10, v7 row_newbcast:0 row_mask:0xf bank_mask:0xf
  v_and_b32_dpp v38, v10, v8 row_newbcast:0 row_mask:0xf bank_mask:0xf
  v_and_b32_dpp v39, v10, v9 row_newbcast:0 row_mask:0xf bank_mask:0xf
  v_and_b32_dpp v40, v10, v6 row_newbcast:8 row_mask:0xf bank_mask:0xf
  v_and_b32_dpp v41, v10, v7 row_newbcast:8 row_mask:0xf bank_mask:0xf
  v_and_b32_dpp v42, v10, v8 row_newbcast:8 row_mask:0xf bank_mask:0xf
  v_and_b32_dpp v43, v10, v9 row_newbcast:8 row_mask:0xf bank_mask:0xf
  v_mfma_f32_16x16x32_bf16 v[32:35], v[36:39], v[128:131], v[32:35]
  s_waitcnt vmcnt(9)
  v_subrev_u32 v53, s61, v52
  v_cmp_gt_u32 vcc, 64, v53
  s_add_u32 s60, s60, 1
  v_mov_b32 v53, s60
  s_bcnt1_i32_b32 s62, vcc_lo
  s_add_u32 s61, s60, 0
  global_load_dword v52, v54, s[58:59] sc0
  s_mov_b64 exec, 1
  global_store_dword v55, v53, s[58:59]
  s_mov_b64 exec, -1
  s_cmp_ge_u32 s62, 28
  s_cselect_b64 vcc, -1, 0
  s_cbranch_vccnz L_c81
  s_waitcnt vmcnt(6)
L_c81:
  s_waitcnt vmcnt(8)
  buffer_load_dwordx4 v[128:131], v1, s[44:47], s13 offen offset:0 nt
  v_and_b32_dpp v36, v10, v6 row_newbcast:4 row_mask:0xf bank_mask:0xf
  v_and_b32_dpp v37, v10, v7 row_newbcast:4 row_mask:0xf bank_mask:0xf
  v_and_b32_dpp v38, v10, v8 row_newbcast:4 row_mask:0xf bank_mask:0xf
  v_and_b32_dpp v39, v10, v9 row_newbcast:4 row_mask:0xf bank_mask:0xf
  v_mfma_f32_16x16x32_bf16 v[32:35], v[40:43], v[132:135], v[32:35]
  s_cbranch_vccnz L_c82
  s_waitcnt vmcnt(6)
L_c82:
  s_waitcnt vmcnt(8)
  buffer_load_dwordx4 v[132:135], v1, s[44:47], s13 offen offset:1024 nt
  v_and_b32_dpp v40, v10, v6 row_newbcast:12 row_mask:0xf bank_mask:0xf
  v_and_b32_dpp v41, v10, v7 row_newbcast:12 row_mask:0xf bank_mask:0xf
  v_and_b32_dpp v42, v10, v8 row_newbcast:12 row_mask:0xf bank_mask:0xf
  v_and_b32_dpp v43, v10, v9 row_newbcast:12 row_mask:0xf bank_mask:0xf
  v_mfma_f32_16x16x32_bf16 v[32:35], v[36:39], v[136:139], v[32:35]
  s_cbranch_vccnz L_c83
  s_waitcnt vmcnt(6)
L_c83:
  s_waitcnt vmcnt(8)
  buffer_load_dwordx4 v[136:139], v1, s[44:47], s13 offen offset:2048 nt
  v_and_b32_dpp v36, v10, v6 row_newbcast:2 row_mask:0xf bank_mask:0xf
  v_and_b32_dpp v37, v10, v7 row_newbcast:2 row_mask:0xf bank_mask:0xf
  v_and_b32_dpp v38, v10, v8 row_newbcast:2 row_mask:0xf bank_mask:0xf
  v_and_b32_dpp v39, v10, v9 row_newbcast:2 row_mask:0xf bank_mask:0xf
  v_mfma_f32_16x16x32_bf16 v[32:35], v[40:43], v[140:143], v[32:35]
  s_cbranch_vccnz L_c84
  s_waitcnt vmcnt(6)
L_c84:
  s_waitcnt vmcnt(8)
  buffer_load_dwordx4 v[140:143], v1, s[44:47], s13 offen offset:3072 nt
  s_xor_b32 s13, s13, 0x40000
  v_and_b32_dpp v40, v10, v6 row_newbcast:10 row_mask:0xf bank_mask:0xf
  v_and_b32_dpp v41, v10, v7 row_newbcast:10 row_mask:0xf bank_mask:0xf
  v_and_b32_dpp v42, v10, v8 row_newbcast:10 row_mask:0xf bank_mask:0xf
  v_and_b32_dpp v43, v10, v9 row_newbcast:10 row_mask:0xf bank_mask:0xf
  v_mfma_f32_16x16x32_bf16 v[32:35], v[36:39], v[144:147], v[32:35]
  s_cbranch_vccnz L_c85
  s_waitcnt vmcnt(6)
L_c85:
  s_waitcnt vmcnt(8)
  buffer_load_dwordx4 v[144:147], v1, s[44:47], s13 offen offset:0 nt
  v_and_b32_dpp v36, v10, v6 row_newbcast:6 row_mask:0xf bank_mask:0xf
  v_and_b32_dpp v37, v10, v7 row_newbcast:6 row_mask:0xf bank_mask:0xf
  v_and_b32_dpp v38, v10, v8 row_newbcast:6 row_mask:0xf bank_mask:0xf
  v_and_b32_dpp v39, v10, v9 row_newbcast:6 row_mask:0xf bank_mask:0xf
  v_mfma_f32_16x16x32_bf16 v[32:35], v[40:43], v[148:151], v[32:35]
  s_cbranch_vccnz L_c86
  s_waitcnt vmcnt(4)
L_c86:
  s_waitcnt vmcnt(8)
  buffer_load_dwordx4 v[148:151], v1, s[44:47], s13 offen offset:1024 nt
  v_and_b32_dpp v40, v10, v6 row_newbcast:14 row_mask:0xf bank_mask:0xf
  v_and_b32_dpp v41, v10, v7 row_newbcast:14 row_mask:0xf bank_mask:0xf
  v_and_b32_dpp v42, v10, v8 row_newbcast:14 row_mask:0xf bank_mask:0xf
  v_and_b32_dpp v43, v10, v9 row_newbcast:14 row_mask:0xf bank_mask:0xf
  v_mfma_f32_16x16x32_bf16 v[32:35], v[36:39], v[152:155], v[32:35]
  s_cbranch_vccnz L_c87
  s_waitcnt vmcnt(4)
L_c87:
  s_waitcnt vmcnt(8)
  buffer_load_dwordx4 v[152:155], v1, s[44:47], s13 offen offset:2048 nt
  v_and_b32_dpp v36, v10, v6 row_newbcast:1 row_mask:0xf bank_mask:0xf
  v_and_b32_dpp v37, v10, v7 row_newbcast:1 row_mask:0xf bank_mask:0xf
  v_and_b32_dpp v38, v10, v8 row_newbcast:1 row_mask:0xf bank_mask:0xf
  v_and_b32_dpp v39, v10, v9 row_newbcast:1 row_mask:0xf bank_mask:0xf
  v_mfma_f32_16x16x32_bf16 v[32:35], v[40:43], v[156:159], v[32:35]
  s_cbranch_vccnz L_c88
  s_waitcnt vmcnt(4)
L_c88:
  s_waitcnt vmcnt(6)
  buffer_load_dwordx4 v[156:159], v1, s[44:47], s13 offen offset:3072 nt
  s_xor_b32 s13, s13, 0x50000
  v_and_b32_dpp v40, v10, v6 row_newbcast:9 row_mask:0xf bank_mask:0xf
  v_and_b32_dpp v41, v10, v7 row_newbcast:9 row_mask:0xf bank_mask:0xf
  v_and_b32_dpp v42, v10, v8 row_newbcast:9 row_mask:0xf bank_mask:0xf
  v_and_b32_dpp v43, v10, v9 row_newbcast:9 row_mask:0xf bank_mask:0xf
  v_mfma_f32_16x16x32_bf16 v[32:35], v[36:39], v[160:163], v[32:35]
  s_waitcnt vmcnt(9)
  v_subrev_u32 v53, s61, v52
  v_cmp_gt_u32 vcc, 64, v53
  s_add_u32 s60, s60, 1
  v_mov_b32 v53, s60
  s_bcnt1_i32_b32 s62, vcc_lo
  s_add_u32 s61, s60, 0
  global_load_dword v52, v54, s[58:59] sc0
  s_mov_b64 exec, 1
  global_store_dword v55, v53, s[58:59]
  s_mov_b64 exec, -1
  s_cmp_ge_u32 s62, 28
  s_cselect_b64 vcc, -1, 0
  s_cbranch_vccnz L_c89
  s_waitcnt vmcnt(6)
L_c89:
  s_waitcnt vmcnt(8)
  buffer_load_dwordx4 v[160:163], v1, s[44:47], s13 offen offset:0 nt
  v_and_b32_dpp v36, v10, v6 row_newbcast:5 row_mask:0xf bank_mask:0xf
  v_and_b32_dpp v37, v10, v7 row_newbcast:5 row_mask:0xf bank_mask:0xf
  v_and_b32_dpp v38, v10, v8 row_newbcast:5 row_mask:0xf bank_mask:0xf
  v_and_b32_dpp v39, v10, v9 row_newbcast:5 row_mask:0xf bank_mask:0xf
  v_mfma_f32_16x16x32_bf16 v[32:35], v[40:43], v[164:167], v[32:35]
  s_cbranch_vccnz L_c90
  s_waitcnt vmcnt(6)
L_c90:
  s_waitcnt vmcnt(8)
  buffer_load_dwordx4 v[164:167], v1, s[44:47], s13 offen offset:1024 nt
  v_and_b32_dpp v40, v10, v6 row_newbcast:13 row_mask:0xf bank_mask:0xf
  v_and_b32_dpp v41, v10, v7 row_newbcast:13 row_mask:0xf bank_mask:0xf
  v_and_b32_dpp v42, v10, v8 row_newbcast:13 row_mask:0xf bank_mask:0xf
  v_and_b32_dpp v43, v10, v9 row_newbcast:13 row_mask:0xf bank_mask:0xf
  v_mfma_f32_16x16x32_bf16 v[32:35], v[36:39], v[168:171], v[32:35]
  s_cbranch_vccnz L_c91
  s_waitcnt vmcnt(6)
L_c91:
  s_waitcnt vmcnt(8)
  buffer_load_dwordx4 v[168:171], v1, s[44:47], s13 offen offset:2048 nt
  v_and_b32_dpp v36, v10, v6 row_newbcast:3 row_mask:0xf bank_mask:0xf
  v_and_b32_dpp v37, v10, v7 row_newbcast:3 row_mask:0xf bank_mask:0xf
  v_and_b32_dpp v38, v10, v8 row_newbcast:3 row_mask:0xf bank_mask:0xf
  v_and_b32_dpp v39, v10, v9 row_newbcast:3 row_mask:0xf bank_mask:0xf
  v_mfma_f32_16x16x32_bf16 v[32:35], v[40:43], v[172:175], v[32:35]
  s_cbranch_vccnz L_c92
  s_waitcnt vmcnt(6)
L_c92:
  s_waitcnt vmcnt(8)
  buffer_load_dwordx4 v[172:175], v1, s[44:47], s13 offen offset:3072 nt
  s_xor_b32 s13, s13, 0x40000
  v_and_b32_dpp v40, v10, v6 row_newbcast:11 row_mask:0xf bank_mask:0xf
  v_and_b32_dpp v41, v10, v7 row_newbcast:11 row_mask:0xf bank_mask:0xf
  v_and_b32_dpp v42, v10, v8 row_newbcast:11 row_mask:0xf bank_mask:0xf
  v_and_b32_dpp v43, v10, v9 row_newbcast:11 row_mask:0xf bank_mask:0xf
  v_mfma_f32_16x16x32_bf16 v[32:35], v[36:39], v[176:179], v[32:35]
  s_cbranch_vccnz L_c93
  s_waitcnt vmcnt(6)
L_c93:
  s_waitcnt vmcnt(8)
  buffer_load_dwordx4 v[176:179], v1, s[44:47], s13 offen offset:0 nt
  v_and_b32_dpp v36, v10, v6 row_newbcast:7 row_mask:0xf bank_mask:0xf
  v_and_b32_dpp v37, v10, v7 row_newbcast:7 row_mask:0xf bank_mask:0xf
  v_and_b32_dpp v38, v10, v8 row_newbcast:7 row_mask:0xf bank_mask:0xf
  v_and_b32_dpp v39, v10, v9 row_newbcast:7 row_mask:0xf bank_mask:0xf
  v_mfma_f32_16x16x32_bf16 v[32:35], v[40:43], v[180:183], v[32:35]
  s_cbranch_vccnz L_c94
  s_waitcnt vmcnt(4)
L_c94:
  s_waitcnt vmcnt(8)
  buffer_load_dwordx4 v[180:183], v1, s[44:47], s13 offen offset:1024 nt
  v_and_b32_dpp v40, v10, v6 row_newbcast:15 row_mask:0xf bank_mask:0xf
  v_and_b32_dpp v41, v10, v7 row_newbcast:15 row_mask:0xf bank_mask:0xf
  v_and_b32_dpp v42, v10, v8 row_newbcast:15 row_mask:0xf bank_mask:0xf
  v_and_b32_dpp v43, v10, v9 row_newbcast:15 row_mask:0xf bank_mask:0xf
  v_mfma_f32_16x16x32_bf16 v[32:35], v[36:39], v[184:187], v[32:35]
  s_cbranch_vccnz L_c95
  s_waitcnt vmcnt(4)
L_c95:
  s_waitcnt vmcnt(8)
  buffer_load_dwordx4 v[184:187], v1, s[44:47], s13 offen offset:2048 nt
  s_nop 0
  v_mfma_f32_16x16x32_bf16 v[32:35], v[40:43], v[188:191], v[32:35]
  s_cbranch_vccnz L_c96
  s_waitcnt vmcnt(4)
L_c96:
  s_waitcnt vmcnt(6)
  buffer_load_dwordx4 v[188:191], v1, s[44:47], s13 offen offset:3072 nt
  s_or_b32 s57, s57, 0xffe5ffff
  s_add_u32 s57, s57, 1
  s_and_b32 s57, s57, 0x1a0000
  s_xor_b32 s13, s56, s57
  s_add_u32 s14, s14, 1
  v_mov_b32 v10, v11
  v_mov_b32 v11, v12
  v_mov_b32 v12, v13
  v_mov_b32 v13, v14
  v_mov_b32 v14, v15
  v_mov_b32 v15, v16
  v_mov_b32 v16, v17
L_v2:
  v_and_b32_dpp v36, v10, v6 row_newbcast:0 row_mask:0xf bank_mask:0xf
  v_and_b32_dpp v37, v10, v7 row_newbcast:0 row_mask:0xf bank_mask:0xf
  v_and_b32_dpp v38, v10, v8 row_newbcast:0 row_mask:0xf bank_mask:0xf
  v_and_b32_dpp v39, v10, v9 row_newbcast:0 row_mask:0xf bank_mask:0xf
  v_and_b32_dpp v40, v10, v6 row_newbcast:8 row_mask:0xf bank_mask:0xf
  v_and_b32_dpp v41, v10, v7 row_newbcast:8 row_mask:0xf bank_mask:0xf
  v_and_b32_dpp v42, v10, v8 row_newbcast:8 row_mask:0xf bank_mask:0xf
  v_and_b32_dpp v43, v10, v9 row_newbcast:8 row_mask:0xf bank_mask:0xf
  v_mfma_f32_16x16x32_bf16 v[32:35], v[36:39], v[192:195], v[32:35]
  s_waitcnt vmcnt(9)
  v_subrev_u32 v53, s61, v52
  v_cmp_gt_u32 vcc, 64, v53
  s_add_u32 s60, s60, 1
  v_mov_b32 v53, s60
  s_bcnt1_i32_b32 s62, vcc_lo
  s_add_u32 s61, s60, 0
  global_load_dword v52, v54, s[58:59] sc0
  s_mov_b64 exec, 1
  global_store_dword v55, v53, s[58:59]
  s_mov_b64 exec, -1
  s_cmp_ge_u32 s62, 28
  s_cselect_b64 vcc, -1, 0
  s_cbranch_vccnz L_c97
  s_waitcnt vmcnt(6)
L_c97:
  s_waitcnt vmcnt(8)
  buffer_load_dwordx4 v[192:195], v1, s[44:47], s13 offen offset:0 nt
  v_and_b32_dpp v36, v10, v6 row_newbcast:4 row_mask:0xf bank_mask:0xf
  v_and_b32_dpp v37, v10, v7 row_newbcast:4 row_mask:0xf bank_mask:0xf
  v_and_b32_dpp v38, v10, v8 row_newbcast:4 row_mask:0xf bank_mask:0xf
  v_and_b32_dpp v39, v10, v9 row_newbcast:4 row_mask:0xf bank_mask:0xf
  v_mfma_f32_16x16x32_bf16 v[32:35], v[40:43], v[196:199], v[32:35]
  s_cbranch_vccnz L_c98
  s_waitcnt vmcnt(6)
L_c98:
  s_waitcnt vmcnt(8)
  buffer_load_dwordx4 v[196:199], v1, s[44:47], s13 offen offset:1024 nt
  v_and_b32_dpp v40, v10, v6 row_newbcast:12 row_mask:0xf bank_mask:0xf
  v_and_b32_dpp v41, v10, v7 row_newbcast:12 row_mask:0xf bank_mask:0xf
  v_and_b32_dpp v42, v10, v8 row_newbcast:12 row_mask:0xf bank_mask:0xf
  v_and_b32_dpp v43, v10, v9 row_newbcast:12 row_mask:0xf bank_mask:0xf
  v_mfma_f32_16x16x32_bf16 v[32:35], v[36:39], v[200:203], v[32:35]
  s_cbranch_vccnz L_c99
  s_waitcnt vmcnt(6)
L_c99:
  s_waitcnt vmcnt(8)
  buffer_load_dwordx4 v[200:203], v1, s[44:47], s13 offen offset:2048 nt
  v_and_b32_dpp v36, v10, v6 row_newbcast:2 row_mask:0xf bank_mask:0xf
  v_and_b32_dpp v37, v10, v7 row_newbcast:2 row_mask:0xf bank_mask:0xf
  v_and_b32_dpp v38, v10, v8 row_newbcast:2 row_mask:0xf bank_mask:0xf
  v_and_b32_dpp v39, v10, v9 row_newbcast:2 row_mask:0xf bank_mask:0xf
  v_mfma_f32_16x16x32_bf16 v[32:35], v[40:43], v[204:207], v[32:35]
  s_cbranch_vccnz L_c100
  s_waitcnt vmcnt(6)
L_c100:
  s_waitcnt vmcnt(8)
  buffer_load_dwordx4 v[204:207], v1, s[44:47], s13 offen offset:3072 nt
  s_xor_b32 s13, s13, 0x40000
  v_and_b32_dpp v40, v10, v6 row_newbcast:10 row_mask:0xf bank_mask:0xf
  v_and_b32_dpp v41, v10, v7 row_newbcast:10 row_mask:0xf bank_mask:0xf
  v_and_b32_dpp v42, v10, v8 row_newbcast:10 row_mask:0xf bank_mask:0xf
  v_and_b32_dpp v43, v10, v9 row_newbcast:10 row_mask:0xf bank_mask:0xf
  v_mfma_f32_16x16x32_bf16 v[32:35], v[36:39], v[208:211], v[32:35]
  s_cbranch_vccnz L_c101
  s_waitcnt vmcnt(6)
L_c101:
  s_waitcnt vmcnt(8)
  buffer_load_dwordx4 v[208:211], v1, s[44:47], s13 offen offset:0 nt
  v_and_b32_dpp v36, v10, v6 row_newbcast:6 row_mask:0xf bank_mask:0xf
  v_and_b32_dpp v37, v10, v7 row_newbcast:6 row_mask:0xf bank_mask:0xf
  v_and_b32_dpp v38, v10, v8 row_newbcast:6 row_mask:0xf bank_mask:0xf
  v_and_b32_dpp v39, v10, v9 row_newbcast:6 row_mask:0xf bank_mask:0xf
  v_mfma_f32_16x16x32_bf16 v[32:35], v[40:43], v[212:215], v[32:35]
  s_cbranch_vccnz L_c102
  s_waitcnt vmcnt(4)
L_c102:
  s_waitcnt vmcnt(8)
  buffer_load_dwordx4 v[212:215], v1, s[44:47], s13 offen offset:1024 nt
  v_and_b32_dpp v40, v10, v6 row_newbcast:14 row_mask:0xf bank_mask:0xf
  v_and_b32_dpp v41, v10, v7 row_newbcast:14 row_mask:0xf bank_mask:0xf
  v_and_b32_dpp v42, v10, v8 row_newbcast:14 row_mask:0xf bank_mask:0xf
  v_and_b32_dpp v43, v10, v9 row_newbcast:14 row_mask:0xf bank_mask:0xf
  v_mfma_f32_16x16x32_bf16 v[32:35], v[36:39], v[216:219], v[32:35]
  s_cbranch_vccnz L_c103
  s_waitcnt vmcnt(4)
L_c103:
  s_waitcnt vmcnt(8)
  buffer_load_dwordx4 v[216:219], v1, s[44:47], s13 offen offset:2048 nt
  v_and_b32_dpp v36, v10, v6 row_newbcast:1 row_mask:0xf bank_mask:0xf
  v_and_b32_dpp v37, v10, v7 row_newbcast:1 row_mask:0xf bank_mask:0xf
  v_and_b32_dpp v38, v10, v8 row_newbcast:1 row_mask:0xf bank_mask:0xf
  v_and_b32_dpp v39, v10, v9 row_newbcast:1 row_mask:0xf bank_mask:0xf
  v_mfma_f32_16x16x32_bf16 v[32:35], v[40:43], v[220:223], v[32:35]
  s_cbranch_vccnz L_c104
  s_waitcnt vmcnt(4)
L_c104:
  s_waitcnt vmcnt(6)
  buffer_load_dwordx4 v[220:223], v1, s[44:47], s13 offen offset:3072 nt
  s_xor_b32 s13, s13, 0x50000
  v_and_b32_dpp v40, v10, v6 row_newbcast:9 row_mask:0xf bank_mask:0xf
  v_and_b32_dpp v41, v10, v7 row_newbcast:9 row_mask:0xf bank_mask:0xf
  v_and_b32_dpp v42, v10, v8 row_newbcast:9 row_mask:0xf bank_mask:0xf
  v_and_b32_dpp v43, v10, v9 row_newbcast:9 row_mask:0xf bank_mask:0xf
  v_mfma_f32_16x16x32_bf16 v[32:35], v[36:39], v[224:227], v[32:35]
  s_waitcnt vmcnt(9)
  v_subrev_u32 v53, s61, v52
  v_cmp_gt_u32 vcc, 64, v53
  s_add_u32 s60, s60, 1
  v_mov_b32 v53, s60
  s_bcnt1_i32_b32 s62, vcc_lo
  s_add_u32 s61, s60, 0
  global_load_dword v52, v54, s[58:59] sc0
  s_mov_b64 exec, 1
  global_store_dword v55, v53, s[58:59]
  s_mov_b64 exec, -1
  s_cmp_ge_u32 s62, 28
  s_cselect_b64 vcc, -1, 0
  s_cbranch_vccnz L_c105
  s_waitcnt vmcnt(6)
L_c105:
  s_waitcnt vmcnt(8)
  buffer_load_dwordx4 v[224:227], v1, s[44:47], s13 offen offset:0 nt
  v_and_b32_dpp v36, v10, v6 row_newbcast:5 row_mask:0xf bank_mask:0xf
  v_and_b32_dpp v37, v10, v7 row_newbcast:5 row_mask:0xf bank_mask:0xf
  v_and_b32_dpp v38, v10, v8 row_newbcast:5 row_mask:0xf bank_mask:0xf
  v_and_b32_dpp v39, v10, v9 row_newbcast:5 row_mask:0xf bank_mask:0xf
  v_mfma_f32_16x16x32_bf16 v[32:35], v[40:43], v[228:231], v[32:35]
  s_cbranch_vccnz L_c106
  s_waitcnt vmcnt(6)
L_c106:
  s_waitcnt vmcnt(8)
  buffer_load_dwordx4 v[228:231], v1, s[44:47], s13 offen offset:1024 nt
  v_and_b32_dpp v40, v10, v6 row_newbcast:13 row_mask:0xf bank_mask:0xf
  v_and_b32_dpp v41, v10, v7 row_newbcast:13 row_mask:0xf bank_mask:0xf
  v_and_b32_dpp v42, v10, v8 row_newbcast:13 row_mask:0xf bank_mask:0xf
  v_and_b32_dpp v43, v10, v9 row_newbcast:13 row_mask:0xf bank_mask:0xf
  v_mfma_f32_16x16x32_bf16 v[32:35], v[36:39], v[232:235], v[32:35]
  s_cbranch_vccnz L_c107
  s_waitcnt vmcnt(6)
L_c107:
  s_waitcnt vmcnt(8)
  buffer_load_dwordx4 v[232:235], v1, s[44:47], s13 offen offset:2048 nt
  v_and_b32_dpp v36, v10, v6 row_newbcast:3 row_mask:0xf bank_mask:0xf
  v_and_b32_dpp v37, v10, v7 row_newbcast:3 row_mask:0xf bank_mask:0xf
  v_and_b32_dpp v38, v10, v8 row_newbcast:3 row_mask:0xf bank_mask:0xf
  v_and_b32_dpp v39, v10, v9 row_newbcast:3 row_mask:0xf bank_mask:0xf
  v_mfma_f32_16x16x32_bf16 v[32:35], v[40:43], v[236:239], v[32:35]
  s_cbranch_vccnz L_c108
  s_waitcnt vmcnt(6)
L_c108:
  s_waitcnt vmcnt(8)
  buffer_load_dwordx4 v[236:239], v1, s[44:47], s13 offen offset:3072 nt
  s_xor_b32 s13, s13, 0x40000
  v_and_b32_dpp v40, v10, v6 row_newbcast:11 row_mask:0xf bank_mask:0xf
  v_and_b32_dpp v41, v10, v7 row_newbcast:11 row_mask:0xf bank_mask:0xf
  v_and_b32_dpp v42, v10, v8 row_newbcast:11 row_mask:0xf bank_mask:0xf
  v_and_b32_dpp v43, v10, v9 row_newbcast:11 row_mask:0xf bank_mask:0xf
  v_mfma_f32_16x16x32_bf16 v[32:35], v[36:39], v[240:243], v[32:35]
  s_cbranch_vccnz L_c109
  s_waitcnt vmcnt(6)
L_c109:
  s_waitcnt vmcnt(8)
  buffer_load_dwordx4 v[240:243], v1, s[44:47], s13 offen offset:0 nt
  v_and_b32_dpp v36, v10, v6 row_newbcast:7 row_mask:0xf bank_mask:0xf
  v_and_b32_dpp v37, v10, v7 row_newbcast:7 row_mask:0xf bank_mask:0xf
  v_and_b32_dpp v38, v10, v8 row_newbcast:7 row_mask:0xf bank_mask:0xf
  v_and_b32_dpp v39, v10, v9 row_newbcast:7 row_mask:0xf bank_mask:0xf
  v_mfma_f32_16x16x32_bf16 v[32:35], v[40:43], v[244:247], v[32:35]
  s_cbranch_vccnz L_c110
  s_waitcnt vmcnt(4)
L_c110:
  s_waitcnt vmcnt(8)
  buffer_load_dwordx4 v[244:247], v1, s[44:47], s13 offen offset:1024 nt
  v_and_b32_dpp v40, v10, v6 row_newbcast:15 row_mask:0xf bank_mask:0xf
  v_and_b32_dpp v41, v10, v7 row_newbcast:15 row_mask:0xf bank_mask:0xf
  v_and_b32_dpp v42, v10, v8 row_newbcast:15 row_mask:0xf bank_mask:0xf
  v_and_b32_dpp v43, v10, v9 row_newbcast:15 row_mask:0xf bank_mask:0xf
  v_mfma_f32_16x16x32_bf16 v[32:35], v[36:39], v[248:251], v[32:35]
  s_cbranch_vccnz L_c111
  s_waitcnt vmcnt(4)
L_c111:
  s_waitcnt vmcnt(8)
  buffer_load_dwordx4 v[248:251], v1, s[44:47], s13 offen offset:2048 nt
  s_nop 0
  v_mfma_f32_16x16x32_bf16 v[32:35], v[40:43], v[252:255], v[32:35]
  s_cbranch_vccnz L_c112
  s_waitcnt vmcnt(4)
L_c112:
  s_waitcnt vmcnt(6)
  buffer_load_dwordx4 v[252:255], v1, s[44:47], s13 offen offset:3072 nt
  s_or_b32 s57, s57, 0xffe5ffff
  s_add_u32 s57, s57, 1
  s_and_b32 s57, s57, 0x1a0000
  s_xor_b32 s13, s56, s57
  s_add_u32 s14, s14, 1
  v_mov_b32 v10, v11
  v_mov_b32 v11, v12
  v_mov_b32 v12, v13
  v_mov_b32 v13, v14
  v_mov_b32 v14, v15
  v_mov_b32 v15, v16
  v_mov_b32 v16, v17
  v_and_b32_dpp v36, v10, v6 row_newbcast:0 row_mask:0xf bank_mask:0xf
  v_and_b32_dpp v37, v10, v7 row_newbcast:0 row_mask:0xf bank_mask:0xf
  v_and_b32_dpp v38, v10, v8 row_newbcast:0 row_mask:0xf bank_mask:0xf
  v_and_b32_dpp v39, v10, v9 row_newbcast:0 row_mask:0xf bank_mask:0xf
  v_and_b32_dpp v40, v10, v6 row_newbcast:8 row_mask:0xf bank_mask:0xf
  v_and_b32_dpp v41, v10, v7 row_newbcast:8 row_mask:0xf bank_mask:0xf
  v_and_b32_dpp v42, v10, v8 row_newbcast:8 row_mask:0xf bank_mask:0xf
  v_and_b32_dpp v43, v10, v9 row_newbcast:8 row_mask:0xf bank_mask:0xf
  v_mfma_f32_16x16x32_bf16 v[32:35], v[36:39], v[64:67], v[32:35]
  s_waitcnt vmcnt(9)
  v_subrev_u32 v53, s61, v52
  v_cmp_gt_u32 vcc, 64, v53
  s_add_u32 s60, s60, 1
  v_mov_b32 v53, s60
  s_bcnt1_i32_b32 s62, vcc_lo
  s_add_u32 s61, s60, 0
  global_load_dword v52, v54, s[58:59] sc0
  s_mov_b64 exec, 1
  global_store_dword v55, v53, s[58:59]
  s_mov_b64 exec, -1
  s_cmp_ge_u32 s62, 28
  s_cselect_b64 vcc, -1, 0
  s_cmp_eq_u32 s14, 15
  s_cselect_b64 vcc, -1, vcc
  s_cbranch_vccnz L_c113
  s_waitcnt vmcnt(6)
L_c113:
  s_waitcnt vmcnt(8)
  buffer_load_dwordx4 v[64:67], v1, s[44:47], s13 offen offset:0 nt
  v_and_b32_dpp v36, v10, v6 row_newbcast:4 row_mask:0xf bank_mask:0xf
  v_and_b32_dpp v37, v10, v7 row_newbcast:4 row_mask:0xf bank_mask:0xf
  v_and_b32_dpp v38, v10, v8 row_newbcast:4 row_mask:0xf bank_mask:0xf
  v_and_b32_dpp v39, v10, v9 row_newbcast:4 row_mask:0xf bank_mask:0xf
  v_mfma_f32_16x16x32_bf16 v[32:35], v[40:43], v[68:71], v[32:35]
  s_cbranch_vccnz L_c114
  s_waitcnt vmcnt(6)
L_c114:
  s_waitcnt vmcnt(8)
  buffer_load_dwordx4 v[68:71], v1, s[44:47], s13 offen offset:1024 nt
  v_and_b32_dpp v40, v10, v6 row_newbcast:12 row_mask:0xf bank_mask:0xf
  v_and_b32_dpp v41, v10, v7 row_newbcast:12 row_mask:0xf bank_mask:0xf
  v_and_b32_dpp v42, v10, v8 row_newbcast:12 row_mask:0xf bank_mask:0xf
  v_and_b32_dpp v43, v10, v9 row_newbcast:12 row_mask:0xf bank_mask:0xf
  v_mfma_f32_16x16x32_bf16 v[32:35], v[36:39], v[72:75], v[32:35]
  s_cbranch_vccnz L_c115
  s_waitcnt vmcnt(6)
L_c115:
  s_waitcnt vmcnt(8)
  buffer_load_dwordx4 v[72:75], v1, s[44:47], s13 offen offset:2048 nt
  v_and_b32_dpp v36, v10, v6 row_newbcast:2 row_mask:0xf bank_mask:0xf
  v_and_b32_dpp v37, v10, v7 row_newbcast:2 row_mask:0xf bank_mask:0xf
  v_and_b32_dpp v38, v10, v8 row_newbcast:2 row_mask:0xf bank_mask:0xf
  v_and_b32_dpp v39, v10, v9 row_newbcast:2 row_mask:0xf bank_mask:0xf
  v_mfma_f32_16x16x32_bf16 v[32:35], v[40:43], v[76:79], v[32:35]
  s_cbranch_vccnz L_c116
  s_waitcnt vmcnt(6)
L_c116:
  s_waitcnt vmcnt(8)
  buffer_load_dwordx4 v[76:79], v1, s[44:47], s13 offen offset:3072 nt
  s_xor_b32 s13, s13, 0x40000
  v_and_b32_dpp v40, v10, v6 row_newbcast:10 row_mask:0xf bank_mask:0xf
  v_and_b32_dpp v41, v10, v7 row_newbcast:10 row_mask:0xf bank_mask:0xf
  v_and_b32_dpp v42, v10, v8 row_newbcast:10 row_mask:0xf bank_mask:0xf
  v_and_b32_dpp v43, v10, v9 row_newbcast:10 row_mask:0xf bank_mask:0xf
  v_mfma_f32_16x16x32_bf16 v[32:35], v[36:39], v[80:83], v[32:35]
  s_cbranch_vccnz L_c117
  s_waitcnt vmcnt(6)
L_c117:
  s_waitcnt vmcnt(8)
  buffer_load_dwordx4 v[80:83], v1, s[44:47], s13 offen offset:0 nt
  v_and_b32_dpp v36, v10, v6 row_newbcast:6 row_mask:0xf bank_mask:0xf
  v_and_b32_dpp v37, v10, v7 row_newbcast:6 row_mask:0xf bank_mask:0xf
  v_and_b32_dpp v38, v10, v8 row_newbcast:6 row_mask:0xf bank_mask:0xf
  v_and_b32_dpp v39, v10, v9 row_newbcast:6 row_mask:0xf bank_mask:0xf
  v_mfma_f32_16x16x32_bf16 v[32:35], v[40:43], v[84:87], v[32:35]
  s_cbranch_vccnz L_c118
  s_waitcnt vmcnt(4)
L_c118:
  s_waitcnt vmcnt(8)
  buffer_load_dwordx4 v[84:87], v1, s[44:47], s13 offen offset:1024 nt
  v_and_b32_dpp v40, v10, v6 row_newbcast:14 row_mask:0xf bank_mask:0xf
  v_and_b32_dpp v41, v10, v7 row_newbcast:14 row_mask:0xf bank_mask:0xf
  v_and_b32_dpp v42, v10, v8 row_newbcast:14 row_mask:0xf bank_mask:0xf
  v_and_b32_dpp v43, v10, v9 row_newbcast:14 row_mask:0xf bank_mask:0xf
  v_mfma_f32_16x16x32_bf16 v[32:35], v[36:39], v[88:91], v[32:35]
  s_cbranch_vccnz L_c119
  s_waitcnt vmcnt(4)
L_c119:
  s_waitcnt vmcnt(8)
  buffer_load_dwordx4 v[88:91], v1, s[44:47], s13 offen offset:2048 nt
  v_and_b32_dpp v36, v10, v6 row_newbcast:1 row_mask:0xf bank_mask:0xf
  v_and_b32_dpp v37, v10, v7 row_newbcast:1 row_mask:0xf bank_mask:0xf
  v_and_b32_dpp v38, v10, v8 row_newbcast:1 row_mask:0xf bank_mask:0xf
  v_and_b32_dpp v39, v10, v9 row_newbcast:1 row_mask:0xf bank_mask:0xf
  v_mfma_f32_16x16x32_bf16 v[32:35], v[40:43], v[92:95], v[32:35]
  s_cbranch_vccnz L_c120
  s_waitcnt vmcnt(4)
L_c120:
  s_waitcnt vmcnt(6)
  buffer_load_dwordx4 v[92:95], v1, s[44:47], s13 offen offset:3072 nt
  s_xor_b32 s13, s13, 0x50000
  v_and_b32_dpp v40, v10, v6 row_newbcast:9 row_mask:0xf bank_mask:0xf
  v_and_b32_dpp v41, v10, v7 row_newbcast:9 row_mask:0xf bank_mask:0xf
  v_and_b32_dpp v42, v10, v8 row_newbcast:9 row_mask:0xf bank_mask:0xf
  v_and_b32_dpp v43, v10, v9 row_newbcast:9 row_mask:0xf bank_mask:0xf
  v_mfma_f32_16x16x32_bf16 v[32:35], v[36:39], v[96:99], v[32:35]
  s_waitcnt vmcnt(9)
  v_subrev_u32 v53, s61, v52
  v_cmp_gt_u32 vcc, 64, v53
  s_add_u32 s60, s60, 1
  v_mov_b32 v53, s60
  s_bcnt1_i32_b32 s62, vcc_lo
  s_add_u32 s61, s60, 0
  global_load_dword v52, v54, s[58:59] sc0
  s_mov_b64 exec, 1
  global_store_dword v55, v53, s[58:59]
  s_mov_b64 exec, -1
  s_cmp_ge_u32 s62, 28
  s_cselect_b64 vcc, -1, 0
  s_cmp_eq_u32 s14, 15
  s_cselect_b64 vcc, -1, vcc
  s_cbranch_vccnz L_c121
  s_waitcnt vmcnt(6)
L_c121:
  s_waitcnt vmcnt(8)
  buffer_load_dwordx4 v[96:99], v1, s[44:47], s13 offen offset:0 nt
  v_and_b32_dpp v36, v10, v6 row_newbcast:5 row_mask:0xf bank_mask:0xf
  v_and_b32_dpp v37, v10, v7 row_newbcast:5 row_mask:0xf bank_mask:0xf
  v_and_b32_dpp v38, v10, v8 row_newbcast:5 row_mask:0xf bank_mask:0xf
  v_and_b32_dpp v39, v10, v9 row_newbcast:5 row_mask:0xf bank_mask:0xf
  v_mfma_f32_16x16x32_bf16 v[32:35], v[40:43], v[100:103], v[32:35]
  s_cbranch_vccnz L_c122
  s_waitcnt vmcnt(6)
L_c122:
  s_waitcnt vmcnt(8)
  buffer_load_dwordx4 v[100:103], v1, s[44:47], s13 offen offset:1024 nt
  v_and_b32_dpp v40, v10, v6 row_newbcast:13 row_mask:0xf bank_mask:0xf
  v_and_b32_dpp v41, v10, v7 row_newbcast:13 row_mask:0xf bank_mask:0xf
  v_and_b32_dpp v42, v10, v8 row_newbcast:13 row_mask:0xf bank_mask:0xf
  v_and_b32_dpp v43, v10, v9 row_newbcast:13 row_mask:0xf bank_mask:0xf
  v_mfma_f32_16x16x32_bf16 v[32:35], v[36:39], v[104:107], v[32:35]
  s_cbranch_vccnz L_c123
  s_waitcnt vmcnt(6)
L_c123:
  s_waitcnt vmcnt(8)
  buffer_load_dwordx4 v[104:107], v1, s[44:47], s13 offen offset:2048 nt
  v_and_b32_dpp v36, v10, v6 row_newbcast:3 row_mask:0xf bank_mask:0xf
  v_and_b32_dpp v37, v10, v7 row_newbcast:3 row_mask:0xf bank_mask:0xf
  v_and_b32_dpp v38, v10, v8 row_newbcast:3 row_mask:0xf bank_mask:0xf
  v_and_b32_dpp v39, v10, v9 row_newbcast:3 row_mask:0xf bank_mask:0xf
  v_mfma_f32_16x16x32_bf16 v[32:35], v[40:43], v[108:111], v[32:35]
  s_cbranch_vccnz L_c124
  s_waitcnt vmcnt(6)
L_c124:
  s_waitcnt vmcnt(8)
  buffer_load_dwordx4 v[108:111], v1, s[44:47], s13 offen offset:3072 nt
  s_xor_b32 s13, s13, 0x40000
  v_and_b32_dpp v40, v10, v6 row_newbcast:11 row_mask:0xf bank_mask:0xf
  v_and_b32_dpp v41, v10, v7 row_newbcast:11 row_mask:0xf bank_mask:0xf
  v_and_b32_dpp v42, v10, v8 row_newbcast:11 row_mask:0xf bank_mask:0xf
  v_and_b32_dpp v43, v10, v9 row_newbcast:11 row_mask:0xf bank_mask:0xf
  v_mfma_f32_16x16x32_bf16 v[32:35], v[36:39], v[112:115], v[32:35]
  s_cbranch_vccnz L_c125
  s_waitcnt vmcnt(6)
L_c125:
  s_waitcnt vmcnt(8)
  buffer_load_dwordx4 v[112:115], v1, s[44:47], s13 offen offset:0 nt
  v_and_b32_dpp v36, v10, v6 row_newbcast:7 row_mask:0xf bank_mask:0xf
  v_and_b32_dpp v37, v10, v7 row_newbcast:7 row_mask:0xf bank_mask:0xf
  v_and_b32_dpp v38, v10, v8 row_newbcast:7 row_mask:0xf bank_mask:0xf
  v_and_b32_dpp v39, v10, v9 row_newbcast:7 row_mask:0xf bank_mask:0xf
  v_mfma_f32_16x16x32_bf16 v[32:35], v[40:43], v[116:119], v[32:35]
  s_cbranch_vccnz L_c126
  s_waitcnt vmcnt(4)
L_c126:
  s_waitcnt vmcnt(8)
  buffer_load_dwordx4 v[116:119], v1, s[44:47], s13 offen offset:1024 nt
  v_and_b32_dpp v40, v10, v6 row_newbcast:15 row_mask:0xf bank_mask:0xf
  v_and_b32_dpp v41, v10, v7 row_newbcast:15 row_mask:0xf bank_mask:0xf
  v_and_b32_dpp v42, v10, v8 row_newbcast:15 row_mask:0xf bank_mask:0xf
  v_and_b32_dpp v43, v10, v9 row_newbcast:15 row_mask:0xf bank_mask:0xf
  v_mfma_f32_16x16x32_bf16 v[32:35], v[36:39], v[120:123], v[32:35]
  s_cbranch_vccnz L_c127
  s_waitcnt vmcnt(4)
L_c127:
  s_waitcnt vmcnt(8)
  buffer_load_dwordx4 v[120:123], v1, s[44:47], s13 offen offset:2048 nt
  s_nop 0
  v_mfma_f32_16x16x32_bf16 v[32:35], v[40:43], v[124:127], v[32:35]
  s_cbranch_vccnz L_c128
  s_waitcnt vmcnt(4)
L_c128:
  s_waitcnt vmcnt(6)
  buffer_load_dwordx4 v[124:127], v1, s[44:47], s13 offen offset:3072 nt
  s_or_b32 s57, s57, 0xffe5ffff
  s_add_u32 s57, s57, 1
  s_and_b32 s57, s57, 0x1a0000
  s_xor_b32 s13, s56, s57
  s_add_u32 s14, s14, 1
  s_cmp_lt_u32 s14, 16
  s_cbranch_scc1 L_vloop
  s_barrier
L_drain:
  v_and_b32_dpp v36, v11, v6 row_newbcast:0 row_mask:0xf bank_mask:0xf
  v_and_b32_dpp v37, v11, v7 row_newbcast:0 row_mask:0xf bank_mask:0xf
  v_and_b32_dpp v38, v11, v8 row_newbcast:0 row_mask:0xf bank_mask:0xf
  v_and_b32_dpp v39, v11, v9 row_newbcast:0 row_mask:0xf bank_mask:0xf
  v_and_b32_dpp v40, v11, v6 row_newbcast:8 row_mask:0xf bank_mask:0xf
  v_and_b32_dpp v41, v11, v7 row_newbcast:8 row_mask:0xf bank_mask:0xf
  v_and_b32_dpp v42, v11, v8 row_newbcast:8 row_mask:0xf bank_mask:0xf
  v_and_b32_dpp v43, v11, v9 row_newbcast:8 row_mask:0xf bank_mask:0xf
  v_mfma_f32_16x16x32_bf16 v[32:35], v[36:39], v[128:131], v[32:35]
  v_and_b32_dpp v36, v11, v6 row_newbcast:4 row_mask:0xf bank_mask:0xf
  v_and_b32_dpp v37, v11, v7 row_newbcast:4 row_mask:0xf bank_mask:0xf
  v_and_b32_dpp v38, v11, v8 row_newbcast:4 row_mask:0xf bank_mask:0xf
  v_and_b32_dpp v39, v11, v9 row_newbcast:4 row_mask:0xf bank_mask:0xf
  v_mfma_f32_16x16x32_bf16 v[32:35], v[40:43], v[132:135], v[32:35]
  v_and_b32_dpp v40, v11, v6 row_newbcast:12 row_mask:0xf bank_mask:0xf
  v_and_b32_dpp v41, v11, v7 row_newbcast:12 row_mask:0xf bank_mask:0xf
  v_and_b32_dpp v42, v11, v8 row_newbcast:12 row_mask:0xf bank_mask:0xf
  v_and_b32_dpp v43, v11, v9 row_newbcast:12 row_mask:0xf bank_mask:0xf
  v_mfma_f32_16x16x32_bf16 v[32:35], v[36:39], v[136:139], v[32:35]
  v_and_b32_dpp v36, v11, v6 row_newbcast:2 row_mask:0xf bank_mask:0xf
  v_and_b32_dpp v37, v11, v7 row_newbcast:2 row_mask:0xf bank_mask:0xf
  v_and_b32_dpp v38, v11, v8 row_newbcast:2 row_mask:0xf bank_mask:0xf
  v_and_b32_dpp v39, v11, v9 row_newbcast:2 row_mask:0xf bank_mask:0xf
  v_mfma_f32_16x16x32_bf16 v[32:35], v[40:43], v[140:143], v[32:35]
  v_and_b32_dpp v40, v11, v6 row_newbcast:10 row_mask:0xf bank_mask:0xf
  v_and_b32_dpp v41, v11, v7 row_newbcast:10 row_mask:0xf bank_mask:0xf
  v_and_b32_dpp v42, v11, v8 row_newbcast:10 row_mask:0xf bank_mask:0xf
  v_and_b32_dpp v43, v11, v9 row_newbcast:10 row_mask:0xf bank_mask:0xf
  v_mfma_f32_16x16x32_bf16 v[32:35], v[36:39], v[144:147], v[32:35]
  v_and_b32_dpp v36, v11, v6 row_newbcast:6 row_mask:0xf bank_mask:0xf
  v_and_b32_dpp v37, v11, v7 row_newbcast:6 row_mask:0xf bank_mask:0xf
  v_and_b32_dpp v38, v11, v8 row_newbcast:6 row_mask:0xf bank_mask:0xf
  v_and_b32_dpp v39, v11, v9 row_newbcast:6 row_mask:0xf bank_mask:0xf
  v_mfma_f32_16x16x32_bf16 v[32:35], v[40:43], v[148:151], v[32:35]
  v_and_b32_dpp v40, v11, v6 row_newbcast:14 row_mask:0xf bank_mask:0xf
  v_and_b32_dpp v41, v11, v7 row_newbcast:14 row_mask:0xf bank_mask:0xf
  v_and_b32_dpp v42, v11, v8 row_newbcast:14 row_mask:0xf bank_mask:0xf
  v_and_b32_dpp v43, v11, v9 row_newbcast:14 row_mask:0xf bank_mask:0xf
  v_mfma_f32_16x16x32_bf16 v[32:35], v[36:39], v[152:155], v[32:35]
  v_and_b32_dpp v36, v11, v6 row_newbcast:1 row_mask:0xf bank_mask:0xf
  v_and_b32_dpp v37, v11, v7 row_newbcast:1 row_mask:0xf bank_mask:0xf
  v_and_b32_dpp v38, v11, v8 row_newbcast:1 row_mask:0xf bank_mask:0xf
  v_and_b32_dpp v39, v11, v9 row_newbcast:1 row_mask:0xf bank_mask:0xf
  v_mfma_f32_16x16x32_bf16 v[32:35], v[40:43], v[156:159], v[32:35]
  v_and_b32_dpp v40, v11, v6 row_newbcast:9 row_mask:0xf bank_mask:0xf
  v_and_b32_dpp v41, v11, v7 row_newbcast:9 row_mask:0xf bank_mask:0xf
  v_and_b32_dpp v42, v11, v8 row_newbcast:9 row_mask:0xf bank_mask:0xf
  v_and_b32_dpp v43, v11, v9 row_newbcast:9 row_mask:0xf bank_mask:0xf
  v_mfma_f32_16x16x32_bf16 v[32:35], v[36:39], v[160:163], v[32:35]
  v_and_b32_dpp v36, v11, v6 row_newbcast:5 row_mask:0xf bank_mask:0xf
  v_and_b32_dpp v37, v11, v7 row_newbcast:5 row_mask:0xf bank_mask:0xf
  v_and_b32_dpp v38, v11, v8 row_newbcast:5 row_mask:0xf bank_mask:0xf
  v_and_b32_dpp v39, v11, v9 row_newbcast:5 row_mask:0xf bank_mask:0xf
  v_mfma_f32_16x16x32_bf16 v[32:35], v[40:43], v[164:167], v[32:35]
  v_and_b32_dpp v40, v11, v6 row_newbcast:13 row_mask:0xf bank_mask:0xf
  v_and_b32_dpp v41, v11, v7 row_newbcast:13 row_mask:0xf bank_mask:0xf
  v_and_b32_dpp v42, v11, v8 row_newbcast:13 row_mask:0xf bank_mask:0xf
  v_and_b32_dpp v43, v11, v9 row_newbcast:13 row_mask:0xf bank_mask:0xf
  v_mfma_f32_16x16x32_bf16 v[32:35], v[36:39], v[168:171], v[32:35]
  v_and_b32_dpp v36, v11, v6 row_newbcast:3 row_mask:0xf bank_mask:0xf
  v_and_b32_dpp v37, v11, v7 row_newbcast:3 row_mask:0xf bank_mask:0xf
  v_and_b32_dpp v38, v11, v8 row_newbcast:3 row_mask:0xf bank_mask:0xf
  v_and_b32_dpp v39, v11, v9 row_newbcast:3 row_mask:0xf bank_mask:0xf
  v_mfma_f32_16x16x32_bf16 v[32:35], v[40:43], v[172:175], v[32:35]
  v_and_b32_dpp v40, v11, v6 row_newbcast:11 row_mask:0xf bank_mask:0xf
  v_and_b32_dpp v41, v11, v7 row_newbcast:11 row_mask:0xf bank_mask:0xf
  v_and_b32_dpp v42, v11, v8 row_newbcast:11 row_mask:0xf bank_mask:0xf
  v_and_b32_dpp v43, v11, v9 row_newbcast:11 row_mask:0xf bank_mask:0xf
  v_mfma_f32_16x16x32_bf16 v[32:35], v[36:39], v[176:179], v[32:35]
  v_and_b32_dpp v36, v11, v6 row_newbcast:7 row_mask:0xf bank_mask:0xf
  v_and_b32_dpp v37, v11, v7 row_newbcast:7 row_mask:0xf bank_mask:0xf
  v_and_b32_dpp v38, v11, v8 row_newbcast:7 row_mask:0xf bank_mask:0xf
  v_and_b32_dpp v39, v11, v9 row_newbcast:7 row_mask:0xf bank_mask:0xf
  v_mfma_f32_16x16x32_bf16 v[32:35], v[40:43], v[180:183], v[32:35]
  v_and_b32_dpp v40, v11, v6 row_newbcast:15 row_mask:0xf bank_mask:0xf
  v_and_b32_dpp v41, v11, v7 row_newbcast:15 row_mask:0xf bank_mask:0xf
  v_and_b32_dpp v42, v11, v8 row_newbcast:15 row_mask:0xf bank_mask:0xf
  v_and_b32_dpp v43, v11, v9 row_newbcast:15 row_mask:0xf bank_mask:0xf
  v_mfma_f32_16x16x32_bf16 v[32:35], v[36:39], v[184:187], v[32:35]
  s_nop 0
  v_mfma_f32_16x16x32_bf16 v[32:35], v[40:43], v[188:191], v[32:35]
  s_cmp_eq_u32 s71, 2
  s_cbranch_scc0 L_now2
  s_mov_b32 s64, s32
  s_mov_b32 s65, s33
  s_mov_b32 s66, 2211840
  s_mov_b32 s67, 0x20000
  s_sub_u32 s11, s2, 112
  s_mul_i32 s68, s11, 13108
  s_lshr_b32 s68, s68, 16
  s_mul_i32 s69, s68, 5
  s_sub_u32 s69, s11, s69
  v_lshrrev_b32 v60, 4, v0
  v_mul_u32_u24 v60, 20480, v60
  v_and_b32 v61, 0xf0, v1
  v_add_u32 v60, v60, v61
  s_mul_i32 s62, s68, 81920
  s_lshl_b32 s11, s69, 8
  s_add_u32 s62, s62, s11
  buffer_load_dwordx4 v[128:131], v60, s[64:67], s62 offen offset:0 nt
  buffer_load_dwordx4 v[132:135], v60, s[64:67], s62 offen offset:1280 nt
  buffer_load_dwordx4 v[136:139], v60, s[64:67], s62 offen offset:2560 nt
  s_add_u32 s62, s62, 3840
  buffer_load_dwordx4 v[140:143], v60, s[64:67], s62 offen offset:0 nt
  buffer_load_dwordx4 v[144:147], v60, s[64:67], s62 offen offset:1280 nt
  buffer_load_dwordx4 v[148:151], v60, s[64:67], s62 offen offset:2560 nt
  s_add_u32 s62, s62, 3840
  buffer_load_dwordx4 v[152:155], v60, s[64:67], s62 offen offset:0 nt
  buffer_load_dwordx4 v[156:159], v60, s[64:67], s62 offen offset:1280 nt
  buffer_load_dwordx4 v[160:163], v60, s[64:67], s62 offen offset:2560 nt
  s_add_u32 s62, s62, 3840
  buffer_load_dwordx4 v[164:167], v60, s[64:67], s62 offen offset:0 nt
  buffer_load_dwordx4 v[168:171], v60, s[64:67], s62 offen offset:1280 nt
  buffer_load_dwordx4 v[172:175], v60, s[64:67], s62 offen offset:2560 nt
  s_add_u32 s62, s62, 3840
  buffer_load_dwordx4 v[176:179], v60, s[64:67], s62 offen offset:0 nt
  buffer_load_dwordx4 v[180:183], v60, s[64:67], s62 offen offset:1280 nt
  buffer_load_dwordx4 v[184:187], v60, s[64:67], s62 offen offset:2560 nt
  s_add_u32 s62, s62, 3840
  buffer_load_dwordx4 v[188:191], v60, s[64:67], s62 offen offset:0 nt
  v_lshlrev_b32 v61, 2, v1
  ds_read_b128 v[16:19], v61 offset:8256
  ds_read_b128 v[20:23], v61 offset:8272
  ds_read_b128 v[24:27], v61 offset:8288
  ds_read_b128 v[44:47], v61 offset:8304
L_now2:
  v_and_b32_dpp v36, v12, v6 row_newbcast:0 row_mask:0xf bank_mask:0xf
  v_and_b32_dpp v37, v12, v7 row_newbcast:0 row_mask:0xf bank_mask:0xf
  v_and_b32_dpp v38, v12, v8 row_newbcast:0 row_mask:0xf bank_mask:0xf
  v_and_b32_dpp v39, v12, v9 row_newbcast:0 row_mask:0xf bank_mask:0xf
  v_and_b32_dpp v40, v12, v6 row_newbcast:8 row_mask:0xf bank_mask:0xf
  v_and_b32_dpp v41, v12, v7 row_newbcast:8 row_mask:0xf bank_mask:0xf
  v_and_b32_dpp v42, v12, v8 row_newbcast:8 row_mask:0xf bank_mask:0xf
  v_and_b32_dpp v43, v12, v9 row_newbcast:8 row_mask:0xf bank_mask:0xf
  v_mfma_f32_16x16x32_bf16 v[32:35], v[36:39], v[192:195], v[32:35]
  v_and_b32_dpp v36, v12, v6 row_newbcast:4 row_mask:0xf bank_mask:0xf
  v_and_b32_dpp v37, v12, v7 row_newbcast:4 row_mask:0xf bank_mask:0xf
  v_and_b32_dpp v38, v12, v8 row_newbcast:4 row_mask:0xf bank_mask:0xf
  v_and_b32_dpp v39, v12, v9 row_newbcast:4 row_mask:0xf bank_mask:0xf
  v_mfma_f32_16x16x32_bf16 v[32:35], v[40:43], v[196:199], v[32:35]
  v_and_b32_dpp v40, v12, v6 row_newbcast:12 row_mask:0xf bank_mask:0xf
  v_and_b32_dpp v41, v12, v7 row_newbcast:12 row_mask:0xf bank_mask:0xf
  v_and_b32_dpp v42, v12, v8 row_newbcast:12 row_mask:0xf bank_mask:0xf
  v_and_b32_dpp v43, v12, v9 row_newbcast:12 row_mask:0xf bank_mask:0xf
  v_mfma_f32_16x16x32_bf16 v[32:35], v[36:39], v[200:203], v[32:35]
  v_and_b32_dpp v36, v12, v6 row_newbcast:2 row_mask:0xf bank_mask:0xf
  v_and_b32_dpp v37, v12, v7 row_newbcast:2 row_mask:0xf bank_mask:0xf
  v_and_b32_dpp v38, v12, v8 row_newbcast:2 row_mask:0xf bank_mask:0xf
  v_and_b32_dpp v39, v12, v9 row_newbcast:2 row_mask:0xf bank_mask:0xf
  v_mfma_f32_16x16x32_bf16 v[32:35], v[40:43], v[204:207], v[32:35]
  v_and_b32_dpp v40, v12, v6 row_newbcast:10 row_mask:0xf bank_mask:0xf
  v_and_b32_dpp v41, v12, v7 row_newbcast:10 row_mask:0xf bank_mask:0xf
  v_and_b32_dpp v42, v12, v8 row_newbcast:10 row_mask:0xf bank_mask:0xf
  v_and_b32_dpp v43, v12, v9 row_newbcast:10 row_mask:0xf bank_mask:0xf
  v_mfma_f32_16x16x32_bf16 v[32:35], v[36:39], v[208:211], v[32:35]
  v_and_b32_dpp v36, v12, v6 row_newbcast:6 row_mask:0xf bank_mask:0xf
  v_and_b32_dpp v37, v12, v7 row_newbcast:6 row_mask:0xf bank_mask:0xf
  v_and_b32_dpp v38, v12, v8 row_newbcast:6 row_mask:0xf bank_mask:0xf
  v_and_b32_dpp v39, v12, v9 row_newbcast:6 row_mask:0xf bank_mask:0xf
  v_mfma_f32_16x16x32_bf16 v[32:35], v[40:43], v[212:215], v[32:35]
  v_and_b32_dpp v40, v12, v6 row_newbcast:14 row_mask:0xf bank_mask:0xf
  v_and_b32_dpp v41, v12, v7 row_newbcast:14 row_mask:0xf bank_mask:0xf
  v_and_b32_dpp v42, v12, v8 row_newbcast:14 row_mask:0xf bank_mask:0xf
  v_and_b32_dpp v43, v12, v9 row_newbcast:14 row_mask:0xf bank_mask:0xf
  v_mfma_f32_16x16x32_bf16 v[32:35], v[36:39], v[216:219], v[32:35]
  v_and_b32_dpp v36, v12, v6 row_newbcast:1 row_mask:0xf bank_mask:0xf
  v_and_b32_dpp v37, v12, v7 row_newbcast:1 row_mask:0xf bank_mask:0xf
  v_and_b32_dpp v38, v12, v8 row_newbcast:1 row_mask:0xf bank_mask:0xf
  v_and_b32_dpp v39, v12, v9 row_newbcast:1 row_mask:0xf bank_mask:0xf
  v_mfma_f32_16x16x32_bf16 v[32:35], v[40:43], v[220:223], v[32:35]
  v_and_b32_dpp v40, v12, v6 row_newbcast:9 row_mask:0xf bank_mask:0xf
  v_and_b32_dpp v41, v12, v7 row_newbcast:9 row_mask:0xf bank_mask:0xf
  v_and_b32_dpp v42, v12, v8 row_newbcast:9 row_mask:0xf bank_mask:0xf
  v_and_b32_dpp v43, v12, v9 row_newbcast:9 row_mask:0xf bank_mask:0xf
  v_mfma_f32_16x16x32_bf16 v[32:35], v[36:39], v[224:227], v[32:35]
  v_and_b32_dpp v36, v12, v6 row_newbcast:5 row_mask:0xf bank_mask:0xf
  v_and_b32_dpp v37, v12, v7 row_newbcast:5 row_mask:0xf bank_mask:0xf
  v_and_b32_dpp v38, v12, v8 row_newbcast:5 row_mask:0xf bank_mask:0xf
  v_and_b32_dpp v39, v12, v9 row_newbcast:5 row_mask:0xf bank_mask:0xf
  v_mfma_f32_16x16x32_bf16 v[32:35], v[40:43], v[228:231], v[32:35]
  v_and_b32_dpp v40, v12, v6 row_newbcast:13 row_mask:0xf bank_mask:0xf
  v_and_b32_dpp v41, v12, v7 row_newbcast:13 row_mask:0xf bank_mask:0xf
  v_and_b32_dpp v42, v12, v8 row_newbcast:13 row_mask:0xf bank_mask:0xf
  v_and_b32_dpp v43, v12, v9 row_newbcast:13 row_mask:0xf bank_mask:0xf
  v_mfma_f32_16x16x32_bf16 v[32:35], v[36:39], v[232:235], v[32:35]
  v_and_b32_dpp v36, v12, v6 row_newbcast:3 row_mask:0xf bank_mask:0xf
  v_and_b32_dpp v37, v12, v7 row_newbcast:3 row_mask:0xf bank_mask:0xf
  v_and_b32_dpp v38, v12, v8 row_newbcast:3 row_mask:0xf bank_mask:0xf
  v_and_b32_dpp v39, v12, v9 row_newbcast:3 row_mask:0xf bank_mask:0xf
  v_mfma_f32_16x16x32_bf16 v[32:35], v[40:43], v[236:239], v[32:35]
  v_and_b32_dpp v40, v12, v6 row_newbcast:11 row_mask:0xf bank_mask:0xf
  v_and_b32_dpp v41, v12, v7 row_newbcast:11 row_mask:0xf bank_mask:0xf
  v_and_b32_dpp v42, v12, v8 row_newbcast:11 row_mask:0xf bank_mask:0xf
  v_and_b32_dpp v43, v12, v9 row_newbcast:11 row_mask:0xf bank_mask:0xf
  v_mfma_f32_16x16x32_bf16 v[32:35], v[36:39], v[240:243], v[32:35]
  v_and_b32_dpp v36, v12, v6 row_newbcast:7 row_mask:0xf bank_mask:0xf
  v_and_b32_dpp v37, v12, v7 row_newbcast:7 row_mask:0xf bank_mask:0xf
  v_and_b32_dpp v38, v12, v8 row_newbcast:7 row_mask:0xf bank_mask:0xf
  v_and_b32_dpp v39, v12, v9 row_newbcast:7 row_mask:0xf bank_mask:0xf
  v_mfma_f32_16x16x32_bf16 v[32:35], v[40:43], v[244:247], v[32:35]
  v_and_b32_dpp v40, v12, v6 row_newbcast:15 row_mask:0xf bank_mask:0xf
  v_and_b32_dpp v41, v12, v7 row_newbcast:15 row_mask:0xf bank_mask:0xf
  v_and_b32_dpp v42, v12, v8 row_newbcast:15 row_mask:0xf bank_mask:0xf
  v_and_b32_dpp v43, v12, v9 row_newbcast:15 row_mask:0xf bank_mask:0xf
  v_mfma_f32_16x16x32_bf16 v[32:35], v[36:39], v[248:251], v[32:35]
  s_nop 0
  v_mfma_f32_16x16x32_bf16 v[32:35], v[40:43], v[252:255], v[32:35]
  s_cmp_eq_u32 s71, 2
  v_and_b32_dpp v36, v13, v6 row_newbcast:0 row_mask:0xf bank_mask:0xf
  v_and_b32_dpp v37, v13, v7 row_newbcast:0 row_mask:0xf bank_mask:0xf
  v_and_b32_dpp v38, v13, v8 row_newbcast:0 row_mask:0xf bank_mask:0xf
  v_and_b32_dpp v39, v13, v9 row_newbcast:0 row_mask:0xf bank_mask:0xf
  v_and_b32_dpp v40, v13, v6 row_newbcast:8 row_mask:0xf bank_mask:0xf
  v_and_b32_dpp v41, v13, v7 row_newbcast:8 row_mask:0xf bank_mask:0xf
  v_and_b32_dpp v42, v13, v8 row_newbcast:8 row_mask:0xf bank_mask:0xf
  v_and_b32_dpp v43, v13, v9 row_newbcast:8 row_mask:0xf bank_mask:0xf
  s_cbranch_scc1 L_c129
  s_waitcnt vmcnt(15)
L_c129:
  s_waitcnt vmcnt(31)
  v_mfma_f32_16x16x32_bf16 v[32:35], v[36:39], v[64:67], v[32:35]
  v_and_b32_dpp v36, v13, v6 row_newbcast:4 row_mask:0xf bank_mask:0xf
  v_and_b32_dpp v37, v13, v7 row_newbcast:4 row_mask:0xf bank_mask:0xf
  v_and_b32_dpp v38, v13, v8 row_newbcast:4 row_mask:0xf bank_mask:0xf
  v_and_b32_dpp v39, v13, v9 row_newbcast:4 row_mask:0xf bank_mask:0xf
  s_cbranch_scc1 L_c130
  s_waitcnt vmcnt(14)
L_c130:
  s_waitcnt vmcnt(30)
  v_mfma_f32_16x16x32_bf16 v[32:35], v[40:43], v[68:71], v[32:35]
  v_and_b32_dpp v40, v13, v6 row_newbcast:12 row_mask:0xf bank_mask:0xf
  v_and_b32_dpp v41, v13, v7 row_newbcast:12 row_mask:0xf bank_mask:0xf
  v_and_b32_dpp v42, v13, v8 row_newbcast:12 row_mask:0xf bank_mask:0xf
  v_and_b32_dpp v43, v13, v9 row_newbcast:12 row_mask:0xf bank_mask:0xf
  s_cbranch_scc1 L_c131
  s_waitcnt vmcnt(13)
L_c131:
  s_waitcnt vmcnt(29)
  v_mfma_f32_16x16x32_bf16 v[32:35], v[36:39], v[72:75], v[32:35]
  v_and_b32_dpp v36, v13, v6 row_newbcast:2 row_mask:0xf bank_mask:0xf
  v_and_b32_dpp v37, v13, v7 row_newbcast:2 row_mask:0xf bank_mask:0xf
  v_and_b32_dpp v38, v13, v8 row_newbcast:2 row_mask:0xf bank_mask:0xf
  v_and_b32_dpp v39, v13, v9 row_newbcast:2 row_mask:0xf bank_mask:0xf
  s_cbranch_scc1 L_c132
  s_waitcnt vmcnt(12)
L_c132:
  s_waitcnt vmcnt(28)
  v_mfma_f32_16x16x32_bf16 v[32:35], v[40:43], v[76:79], v[32:35]
  v_and_b32_dpp v40, v13, v6 row_newbcast:10 row_mask:0xf bank_mask:0xf
  v_and_b32_dpp v41, v13, v7 row_newbcast:10 row_mask:0xf bank_mask:0xf
  v_and_b32_dpp v42, v13, v8 row_newbcast:10 row_mask:0xf bank_mask:0xf
  v_and_b32_dpp v43, v13, v9 row_newbcast:10 row_mask:0xf bank_mask:0xf
  s_cbranch_scc1 L_c133
  s_waitcnt vmcnt(11)
L_c133:
  s_waitcnt vmcnt(27)
  v_mfma_f32_16x16x32_bf16 v[32:35], v[36:39], v[80:83], v[32:35]
  v_and_b32_dpp v36, v13, v6 row_newbcast:6 row_mask:0xf bank_mask:0xf
  v_and_b32_dpp v37, v13, v7 row_newbcast:6 row_mask:0xf bank_mask:0xf
  v_and_b32_dpp v38, v13, v8 row_newbcast:6 row_mask:0xf bank_mask:0xf
  v_and_b32_dpp v39, v13, v9 row_newbcast:6 row_mask:0xf bank_mask:0xf
  s_cbranch_scc1 L_c134
  s_waitcnt vmcnt(10)
L_c134:
  s_waitcnt vmcnt(26)
  v_mfma_f32_16x16x32_bf16 v[32:35], v[40:43], v[84:87], v[32:35]
  v_and_b32_dpp v40, v13, v6 row_newbcast:14 row_mask:0xf bank_mask:0xf
  v_and_b32_dpp v41, v13, v7 row_newbcast:14 row_mask:0xf bank_mask:0xf
  v_and_b32_dpp v42, v13, v8 row_newbcast:14 row_mask:0xf bank_mask:0xf
  v_and_b32_dpp v43, v13, v9 row_newbcast:14 row_mask:0xf bank_mask:0xf
  s_cbranch_scc1 L_c135
  s_waitcnt vmcnt(9)
L_c135:
  s_waitcnt vmcnt(25)
  v_mfma_f32_16x16x32_bf16 v[32:35], v[36:39], v[88:91], v[32:35]
  v_and_b32_dpp v36, v13, v6 row_newbcast:1 row_mask:0xf bank_mask:0xf
  v_and_b32_dpp v37, v13, v7 row_newbcast:1 row_mask:0xf bank_mask:0xf
  v_and_b32_dpp v38, v13, v8 row_newbcast:1 row_mask:0xf bank_mask:0xf
  v_and_b32_dpp v39, v13, v9 row_newbcast:1 row_mask:0xf bank_mask:0xf
  s_cbranch_scc1 L_c136
  s_waitcnt vmcnt(8)
L_c136:
  s_waitcnt vmcnt(24)
  v_mfma_f32_16x16x32_bf16 v[32:35], v[40:43], v[92:95], v[32:35]
  v_and_b32_dpp v40, v13, v6 row_newbcast:9 row_mask:0xf bank_mask:0xf
  v_and_b32_dpp v41, v13, v7 row_newbcast:9 row_mask:0xf bank_mask:0xf
  v_and_b32_dpp v42, v13, v8 row_newbcast:9 row_mask:0xf bank_mask:0xf
  v_and_b32_dpp v43, v13, v9 row_newbcast:9 row_mask:0xf bank_mask:0xf
  s_cbranch_scc1 L_c137
  s_waitcnt vmcnt(7)
L_c137:
  s_waitcnt vmcnt(23)
  v_mfma_f32_16x16x32_bf16 v[32:35], v[36:39], v[96:99], v[32:35]
  v_and_b32_dpp v36, v13, v6 row_newbcast:5 row_mask:0xf bank_mask:0xf
  v_and_b32_dpp v37, v13, v7 row_newbcast:5 row_mask:0xf bank_mask:0xf
  v_and_b32_dpp v38, v13, v8 row_newbcast:5 row_mask:0xf bank_mask:0xf
  v_and_b32_dpp v39, v13, v9 row_newbcast:5 row_mask:0xf bank_mask:0xf
  s_cbranch_scc1 L_c138
  s_waitcnt vmcnt(6)
L_c138:
  s_waitcnt vmcnt(22)
  v_mfma_f32_16x16x32_bf16 v[32:35], v[40:43], v[100:103], v[32:35]
  v_and_b32_dpp v40, v13, v6 row_newbcast:13 row_mask:0xf bank_mask:0xf
  v_and_b32_dpp v41, v13, v7 row_newbcast:13 row_mask:0xf bank_mask:0xf
  v_and_b32_dpp v42, v13, v8 row_newbcast:13 row_mask:0xf bank_mask:0xf
  v_and_b32_dpp v43, v13, v9 row_newbcast:13 row_mask:0xf bank_mask:0xf
  s_cbranch_scc1 L_c139
  s_waitcnt vmcnt(5)
L_c139:
  s_waitcnt vmcnt(21)
  v_mfma_f32_16x16x32_bf16 v[32:35], v[36:39], v[104:107], v[32:35]
  v_and_b32_dpp v36, v13, v6 row_newbcast:3 row_mask:0xf bank_mask:0xf
  v_and_b32_dpp v37, v13, v7 row_newbcast:3 row_mask:0xf bank_mask:0xf
  v_and_b32_dpp v38, v13, v8 row_newbcast:3 row_mask:0xf bank_mask:0xf
  v_and_b32_dpp v39, v13, v9 row_newbcast:3 row_mask:0xf bank_mask:0xf
  s_cbranch_scc1 L_c140
  s_waitcnt vmcnt(4)
L_c140:
  s_waitcnt vmcnt(20)
  v_mfma_f32_16x16x32_bf16 v[32:35], v[40:43], v[108:111], v[32:35]
  v_and_b32_dpp v40, v13, v6 row_newbcast:11 row_mask:0xf bank_mask:0xf
  v_and_b32_dpp v41, v13, v7 row_newbcast:11 row_mask:0xf bank_mask:0xf
  v_and_b32_dpp v42, v13, v8 row_newbcast:11 row_mask:0xf bank_mask:0xf
  v_and_b32_dpp v43, v13, v9 row_newbcast:11 row_mask:0xf bank_mask:0xf
  s_cbranch_scc1 L_c141
  s_waitcnt vmcnt(3)
L_c141:
  s_waitcnt vmcnt(19)
  v_mfma_f32_16x16x32_bf16 v[32:35], v[36:39], v[112:115], v[32:35]
  v_and_b32_dpp v36, v13, v6 row_newbcast:7 row_mask:0xf bank_mask:0xf
  v_and_b32_dpp v37, v13, v7 row_newbcast:7 row_mask:0xf bank_mask:0xf
  v_and_b32_dpp v38, v13, v8 row_newbcast:7 row_mask:0xf bank_mask:0xf
  v_and_b32_dpp v39, v13, v9 row_newbcast:7 row_mask:0xf bank_mask:0xf
  s_cbranch_scc1 L_c142
  s_waitcnt vmcnt(2)
L_c142:
  s_waitcnt vmcnt(18)
  v_mfma_f32_16x16x32_bf16 v[32:35], v[40:43], v[116:119], v[32:35]
  v_and_b32_dpp v40, v13, v6 row_newbcast:15 row_mask:0xf bank_mask:0xf
  v_and_b32_dpp v41, v13, v7 row_newbcast:15 row_mask:0xf bank_mask:0xf
  v_and_b32_dpp v42, v13, v8 row_newbcast:15 row_mask:0xf bank_mask:0xf
  v_and_b32_dpp v43, v13, v9 row_newbcast:15 row_mask:0xf bank_mask:0xf
  s_cbranch_scc1 L_c143
  s_waitcnt vmcnt(1)
L_c143:
  s_waitcnt vmcnt(17)
  v_mfma_f32_16x16x32_bf16 v[32:35], v[36:39], v[120:123], v[32:35]
  s_cbranch_scc1 L_c144
  s_waitcnt vmcnt(0)
L_c144:
  s_waitcnt vmcnt(16)
  v_mfma_f32_16x16x32_bf16 v[32:35], v[40:43], v[124:127], v[32:35]
  s_cmp_eq_u32 s71, 1
  s_cbranch_scc1 L_warmed
  s_nop 5
  ds_write_b128 v28, v[32:35] offset:1088
  s_waitcnt lgkmcnt(0)
  s_barrier
  s_cmp_eq_u32 s71, 2
  s_cbranch_scc0 L_send
  s_barrier
  v_and_b32 v36, v16, v6
  v_and_b32 v37, v16, v7
  v_and_b32 v38, v16, v8
  v_and_b32 v39, v16, v9
  v_and_b32 v40, v17, v6
  v_and_b32 v41, v17, v7
  v_and_b32 v42, v17, v8
  v_and_b32 v43, v17, v9
  s_waitcnt vmcnt(15)
  v_mfma_f32_16x16x32_bf16 v[32:35], v[36:39], v[128:131], 0
  v_and_b32 v36, v18, v6
  v_and_b32 v37, v18, v7
  v_and_b32 v38, v18, v8
  v_and_b32 v39, v18, v9
  s_waitcnt vmcnt(14)
  v_mfma_f32_16x16x32_bf16 v[32:35], v[40:43], v[132:135], v[32:35]
  v_and_b32 v40, v19, v6
  v_and_b32 v41, v19, v7
  v_and_b32 v42, v19, v8
  v_and_b32 v43, v19, v9
  s_waitcnt vmcnt(13)
  v_mfma_f32_16x16x32_bf16 v[32:35], v[36:39], v[136:139], v[32:35]
  v_and_b32 v36, v20, v6
  v_and_b32 v37, v20, v7
  v_and_b32 v38, v20, v8
  v_and_b32 v39, v20, v9
  s_waitcnt vmcnt(12)
  v_mfma_f32_16x16x32_bf16 v[32:35], v[40:43], v[140:143], v[32:35]
  v_and_b32 v40, v21, v6
  v_and_b32 v41, v21, v7
  v_and_b32 v42, v21, v8
  v_and_b32 v43, v21, v9
  s_waitcnt vmcnt(11)
  v_mfma_f32_16x16x32_bf16 v[32:35], v[36:39], v[144:147], v[32:35]
  v_and_b32 v36, v22, v6
  v_and_b32 v37, v22, v7
  v_and_b32 v38, v22, v8
  v_and_b32 v39, v22, v9
  s_waitcnt vmcnt(10)
  v_mfma_f32_16x16x32_bf16 v[32:35], v[40:43], v[148:151], v[32:35]
  v_and_b32 v40, v23, v6
  v_and_b32 v41, v23, v7
  v_and_b32 v42, v23, v8
  v_and_b32 v43, v23, v9
  s_waitcnt vmcnt(9)
  v_mfma_f32_16x16x32_bf16 v[32:35], v[36:39], v[152:155], v[32:35]
  v_and_b32 v36, v24, v6
  v_and_b32 v37, v24, v7
  v_and_b32 v38, v24, v8
  v_and_b32 v39, v24, v9
  s_waitcnt vmcnt(8)
  v_mfma_f32_16x16x32_bf16 v[32:35], v[40:43], v[156:159], v[32:35]
  v_and_b32 v40, v25, v6
  v_and_b32 v41, v25, v7
  v_and_b32 v42, v25, v8
  v_and_b32 v43, v25, v9
  s_waitcnt vmcnt(7)
  v_mfma_f32_16x16x32_bf16 v[32:35], v[36:39], v[160:163], v[32:35]
  v_and_b32 v36, v26, v6
  v_and_b32 v37, v26, v7
  v_and_b32 v38, v26, v8
  v_and_b32 v39, v26, v9
  s_waitcnt vmcnt(6)
  v_mfma_f32_16x16x32_bf16 v[32:35], v[40:43], v[164:167], v[32:35]
  v_and_b32 v40, v27, v6
  v_and_b32 v41, v27, v7
  v_and_b32 v42, v27, v8
  v_and_b32 v43, v27, v9
  s_waitcnt vmcnt(5)
  v_mfma_f32_16x16x32_bf16 v[32:35], v[36:39], v[168:171], v[32:35]
  v_and_b32 v36, v44, v6
  v_and_b32 v37, v44, v7
  v_and_b32 v38, v44, v8
  v_and_b32 v39, v44, v9
  s_waitcnt vmcnt(4)
  v_mfma_f32_16x16x32_bf16 v[32:35], v[40:43], v[172:175], v[32:35]
  v_and_b32 v40, v45, v6
  v_and_b32 v41, v45, v7
  v_and_b32 v42, v45, v8
  v_and_b32 v43, v45, v9
  s_waitcnt vmcnt(3)
  v_mfma_f32_16x16x32_bf16 v[32:35], v[36:39], v[176:179], v[32:35]
  v_and_b32 v36, v46, v6
  v_and_b32 v37, v46, v7
  v_and_b32 v38, v46, v8
  v_and_b32 v39, v46, v9
  s_waitcnt vmcnt(2)
  v_mfma_f32_16x16x32_bf16 v[32:35], v[40:43], v[180:183], v[32:35]
  v_and_b32 v40, v47, v6
  v_and_b32 v41, v47, v7
  v_and_b32 v42, v47, v8
  v_and_b32 v43, v47, v9
  s_waitcnt vmcnt(1)
  v_mfma_f32_16x16x32_bf16 v[32:35], v[36:39], v[184:187], v[32:35]
  s_waitcnt vmcnt(0)
  v_mfma_f32_16x16x32_bf16 v[32:35], v[40:43], v[188:191], v[32:35]
  s_mov_b32 s64, s40
  s_mov_b32 s65, s41
  s_mov_b32 s66, 1011840
  s_mov_b32 s67, 0x20000
  v_lshrrev_b32 v18, 5, v0
  v_lshlrev_b32 v18, 9, v18
  v_and_b32 v19, 0x1ff, v28
  v_add_u32 v18, v18, v19
  v_lshrrev_b32 v20, 3, v0
  ds_write_b128 v18, v[32:35] offset:7232
  v_and_b32 v19, 0x30, v1
  v_lshl_add_u32 v19, v20, 6, v19
  v_and_b32 v21, 4, v0
  v_lshl_add_u32 v19, v21, 7, v19
  v_and_b32 v21, 0x70, v1
  v_lshl_add_u32 v21, v20, 12, v21
  s_waitcnt lgkmcnt(0)
  ds_read_b128 v[32:35], v19 offset:7232
  s_lshl_b32 s69, s69, 15
  s_lshl_b32 s68, s68, 7
  s_add_u32 s69, s69, s68
  s_add_u32 s69, s69, 843776
  s_bfe_u32 s11, s60, 0x80008
  v_mov_b32 v20, s11
  s_movk_i32 s11, 0xff00
  s_waitcnt lgkmcnt(0)
  v_and_or_b32 v32, v32, s11, v20
  v_and_or_b32 v33, v33, s11, v20
  v_and_or_b32 v34, v34, s11, v20
  v_and_or_b32 v35, v35, s11, v20
  buffer_store_dwordx4 v[32:35], v21, s[64:67], s69 offen sc1
  s_barrier
L_send:
  s_endpgm
L_helper:
  v_lshrrev_b32 v3, 4, v0
  v_and_b32 v4, 15, v0
  v_bfe_u32 v5, v0, 3, 1
  s_lshr_b32 s13, s2, 3
  s_add_u32 s14, s13, 32
  s_cmp_eq_u32 s10, 0
  s_cselect_b32 s64, s13, s14
  s_cselect_b32 s65, s4, s4
  s_movk_i32 s14, 3456
  s_cselect_b32 s66, 0x2000, s14
  s_cselect_b32 s67, s13, s13
  s_lshl_b32 s67, s67, 8
  s_cmp_lt_u32 s2, 112
  s_cselect_b32 s68, 2, 1
  s_cmp_lt_u32 s10, s68
  s_cselect_b32 s68, 1, 0
  v_and_b32 v1, 7, v0
  v_lshl_add_u32 v1, v3, 3, v1
  v_mul_u32_u24 v1, 40, v1
  v_mul_u32_u24 v20, 1280, v5
  v_add_u32 v1, v1, v20
  s_lshl_b32 s11, s65, 2
  v_add_u32 v2, s11, v3
  v_mul_u32_u24 v2, 40, v2
  v_add_u32 v2, v2, v20
  s_mul_i32 s11, s66, 20
  v_mul_u32_u24 v21, s11, v3
  v_lshl_add_u32 v21, v4, 4, v21
  s_cmp_eq_u32 s64, 45
  s_cselect_b32 s11, 8, 16
  v_cmp_gt_u32 vcc, s11, v4
  v_mov_b32 v22, 0x7ffff000
  s_mul_i32 s12, s65, 80
  v_cndmask_b32 v21, v22, v21, vcc
  s_mul_i32 s12, s12, s66
  s_add_u32 s12, s12, s67
  s_mul_i32 s50, s66, 640
  s_mov_b32 s51, 0x20000
  s_movk_i32 s46, 2560
  s_mov_b32 s47, 0x20000
  s_cmp_eq_u32 s10, 0
  s_waitcnt lgkmcnt(0)
  s_load_dword s42, s[40:41], 1007616
  s_mov_b32 s44, s16
  s_mov_b32 s45, s17
  s_cselect_b32 s48, s22, s28
  s_cselect_b32 s49, s23, s29
  s_cmp_eq_u32 s68, 0
  s_cbranch_scc1 L_noload
  buffer_load_dwordx4 v[30:33], v1, s[44:47], 0 offen
  buffer_load_dwordx4 v[34:37], v1, s[44:47], 0 offen offset:16
  buffer_load_dwordx2 v[38:39], v1, s[44:47], 0 offen offset:32
  buffer_load_dwordx4 v[40:43], v2, s[44:47], 0 offen
  buffer_load_dwordx4 v[44:47], v2, s[44:47], 0 offen offset:16
  buffer_load_dwordx2 v[48:49], v2, s[44:47], 0 offen offset:32
  buffer_load_dwordx4 v[96:99], v21, s[48:51], s12 offen nt
  s_add_u32 s12, s12, s66
  buffer_load_dwordx4 v[100:103], v21, s[48:51], s12 offen nt
  s_add_u32 s12, s12, s66
  buffer_load_dwordx4 v[104:107], v21, s[48:51], s12 offen nt
  s_add_u32 s12, s12, s66
  buffer_load_dwordx4 v[108:111], v21, s[48:51], s12 offen nt
  s_add_u32 s12, s12, s66
  buffer_load_dwordx4 v[112:115], v21, s[48:51], s12 offen nt
  s_add_u32 s12, s12, s66
  buffer_load_dwordx4 v[116:119], v21, s[48:51], s12 offen nt
  s_add_u32 s12, s12, s66
  buffer_load_dwordx4 v[120:123], v21, s[48:51], s12 offen nt
  s_add_u32 s12, s12, s66
  buffer_load_dwordx4 v[124:127], v21, s[48:51], s12 offen nt
  s_add_u32 s12, s12, s66
  buffer_load_dwordx4 v[128:131], v21, s[48:51], s12 offen nt
  s_add_u32 s12, s12, s66
  buffer_load_dwordx4 v[132:135], v21, s[48:51], s12 offen nt
  s_add_u32 s12, s12, s66
  buffer_load_dwordx4 v[136:139], v21, s[48:51], s12 offen nt
  s_add_u32 s12, s12, s66
  buffer_load_dwordx4 v[140:143], v21, s[48:51], s12 offen nt
  s_add_u32 s12, s12, s66
  buffer_load_dwordx4 v[144:147], v21, s[48:51], s12 offen nt
  s_add_u32 s12, s12, s66
  buffer_load_dwordx4 v[148:151], v21, s[48:51], s12 offen nt
  s_add_u32 s12, s12, s66
  buffer_load_dwordx4 v[152:155], v21, s[48:51], s12 offen nt
  s_add_u32 s12, s12, s66
  buffer_load_dwordx4 v[156:159], v21, s[48:51], s12 offen nt
  s_add_u32 s12, s12, s66
  buffer_load_dwordx4 v[160:163], v21, s[48:51], s12 offen nt
  s_add_u32 s12, s12, s66
  buffer_load_dwordx4 v[164:167], v21, s[48:51], s12 offen nt
  s_add_u32 s12, s12, s66
  buffer_load_dwordx4 v[168:171], v21, s[48:51], s12 offen nt
  s_add_u32 s12, s12, s66
  buffer_load_dwordx4 v[172:175], v21, s[48:51], s12 offen nt
L_noload:
  s_mov_b32 s52, s40
  s_mov_b32 s53, s41
  s_mov_b32 s54, 1011840
  s_mov_b32 s55, 0x20000
  v_and_b32 v2, 1, v0
  v_lshlrev_b32 v2, 4, v2
  v_mov_b32 v3, 0xffff
  v_lshlrev_b32 v3, v2, v3
  v_bfe_u32 v2, v0, 1, 2
  v_cmp_eq_u32 vcc, 0, v2
  s_nop 1
  v_cndmask_b32 v6, 0, v3, vcc
  v_cmp_eq_u32 vcc, 1, v2
  s_nop 1
  v_cndmask_b32 v7, 0, v3, vcc
  v_cmp_eq_u32 vcc, 2, v2
  s_nop 1
  v_cndmask_b32 v8, 0, v3, vcc
  v_cmp_eq_u32 vcc, 3, v2
  s_nop 1
  v_cndmask_b32 v9, 0, v3, vcc
  v_lshrrev_b32 v3, 4, v0
  v_lshrrev_b32 v23, 5, v0
  v_lshlrev_b32 v23, 9, v23
  v_lshl_add_u32 v23, v4, 5, v23
  v_and_b32 v24, 16, v0
  v_add_u32 v23, v23, v24
  v_lshrrev_b32 v26, 3, v0
  v_and_b32 v25, 7, v0
  v_lshlrev_b32 v25, 4, v25
  v_lshl_add_u32 v25, v26, 12, v25
  v_and_b32 v24, 3, v0
  v_lshlrev_b32 v24, 4, v24
  v_lshl_add_u32 v24, v26, 6, v24
  v_and_b32 v26, 4, v0
  v_lshl_add_u32 v24, v26, 7, v24
  v_cmp_gt_u32 vcc, 40, v0
  v_mov_b32 v22, 0x7ffff000
  s_mul_i32 s69, s5, 20480
  v_cndmask_b32 v27, v22, v25, vcc
  s_lshl_b32 s11, s6, 7
  s_add_u32 s69, s69, s11
  s_add_u32 s69, s69, 679936
  v_cmp_gt_u32 vcc, 40, v0
  v_lshlrev_b32 v29, 4, v0
  s_lshl_b32 s70, s6, 3
  v_cndmask_b32 v28, v22, v29, vcc
  s_add_u32 s70, s70, s5
  s_mul_i32 s70, s70, 640
  s_add_u32 s70, s70, 376832
  v_mov_b32 v88, v22
  s_sub_u32 s11, s2, 112
  s_mul_i32 s56, s11, 13108
  s_lshr_b32 s56, s56, 16
  s_mul_i32 s57, s56, 5
  s_sub_u32 s57, s11, s57
  s_lshl_b32 s58, s57, 15
  s_lshl_b32 s11, s56, 7
  s_add_u32 s58, s58, s11
  s_add_u32 s58, s58, 843776
  s_waitcnt lgkmcnt(0)
  s_add_u32 s42, s42, 1
  s_and_b32 s43, s42, 0xff
  v_mov_b32 v92, s43
  s_movk_i32 s60, 0xff00
  s_cmp_eq_u32 s68, 0
  s_cbranch_scc0 L_unit
  s_branch L_bar1a
L_unit:
  s_waitcnt vmcnt(23)
  v_lshlrev_b32 v50, 16, v30
  v_and_b32 v51, 0xffff0000, v30
  v_lshlrev_b32 v52, 16, v31
  v_and_b32 v53, 0xffff0000, v31
  v_lshlrev_b32 v54, 16, v32
  v_and_b32 v55, 0xffff0000, v32
  v_lshlrev_b32 v56, 16, v33
  v_and_b32 v57, 0xffff0000, v33
  v_lshlrev_b32 v58, 16, v34
  v_and_b32 v59, 0xffff0000, v34
  v_lshlrev_b32 v60, 16, v35
  v_and_b32 v61, 0xffff0000, v35
  v_lshlrev_b32 v62, 16, v36
  v_and_b32 v63, 0xffff0000, v36
  v_lshlrev_b32 v64, 16, v37
  v_and_b32 v65, 0xffff0000, v37
  v_lshlrev_b32 v66, 16, v38
  v_and_b32 v67, 0xffff0000, v38
  v_lshlrev_b32 v68, 16, v39
  v_and_b32 v69, 0xffff0000, v39
  v_pk_add_f32 v[70:71], v[50:51], v[52:53]
  v_pk_add_f32 v[70:71], v[70:71], v[54:55]
  v_pk_add_f32 v[70:71], v[70:71], v[56:57]
  v_pk_add_f32 v[70:71], v[70:71], v[58:59]
  v_pk_add_f32 v[70:71], v[70:71], v[60:61]
  v_pk_add_f32 v[70:71], v[70:71], v[62:63]
  v_pk_add_f32 v[70:71], v[70:71], v[64:65]
  v_pk_add_f32 v[70:71], v[70:71], v[66:67]
  v_pk_add_f32 v[70:71], v[70:71], v[68:69]
  v_add_f32 v70, v70, v71
  s_nop 1
  v_add_f32_dpp v70, v70, v70 row_half_mirror row_mask:0xf bank_mask:0xf
  s_nop 1
  v_add_f32_dpp v70, v70, v70 quad_perm:[2,3,0,1] row_mask:0xf bank_mask:0xf
  s_nop 1
  v_add_f32_dpp v70, v70, v70 quad_perm:[1,0,3,2] row_mask:0xf bank_mask:0xf
  v_mov_b32 v71, v70
  s_nop 1
  v_permlane16_swap_b32 v70, v71
  s_nop 1
  v_add_f32 v70, v70, v71
  v_mov_b32 v71, v70
  s_nop 1
  v_permlane32_swap_b32 v70, v71
  s_nop 1
  v_add_f32 v70, v70, v71
  s_mov_b32 s11, 0x3acccccd
  v_mul_f32 v70, s11, v70
  v_pk_add_f32 v[50:51], v[50:51], v[70:71] op_sel_hi:[1,0] neg_lo:[0,1] neg_hi:[0,1]
  v_pk_add_f32 v[52:53], v[52:53], v[70:71] op_sel_hi:[1,0] neg_lo:[0,1] neg_hi:[0,1]
  v_pk_add_f32 v[54:55], v[54:55], v[70:71] op_sel_hi:[1,0] neg_lo:[0,1] neg_hi:[0,1]
  v_pk_add_f32 v[56:57], v[56:57], v[70:71] op_sel_hi:[1,0] neg_lo:[0,1] neg_hi:[0,1]
  v_pk_add_f32 v[58:59], v[58:59], v[70:71] op_sel_hi:[1,0] neg_lo:[0,1] neg_hi:[0,1]
  v_pk_add_f32 v[60:61], v[60:61], v[70:71] op_sel_hi:[1,0] neg_lo:[0,1] neg_hi:[0,1]
  v_pk_add_f32 v[62:63], v[62:63], v[70:71] op_sel_hi:[1,0] neg_lo:[0,1] neg_hi:[0,1]
  v_pk_add_f32 v[64:65], v[64:65], v[70:71] op_sel_hi:[1,0] neg_lo:[0,1] neg_hi:[0,1]
  v_pk_add_f32 v[66:67], v[66:67], v[70:71] op_sel_hi:[1,0] neg_lo:[0,1] neg_hi:[0,1]
  v_pk_add_f32 v[68:69], v[68:69], v[70:71] op_sel_hi:[1,0] neg_lo:[0,1] neg_hi:[0,1]
  v_pk_mul_f32 v[72:73], v[50:51], v[50:51]
  v_pk_fma_f32 v[72:73], v[52:53], v[52:53], v[72:73]
  v_pk_fma_f32 v[72:73], v[54:55], v[54:55], v[72:73]
  v_pk_fma_f32 v[72:73], v[56:57], v[56:57], v[72:73]
  v_pk_fma_f32 v[72:73], v[58:59], v[58:59], v[72:73]
  v_pk_fma_f32 v[72:73], v[60:61], v[60:61], v[72:73]
  v_pk_fma_f32 v[72:73], v[62:63], v[62:63], v[72:73]
  v_pk_fma_f32 v[72:73], v[64:65], v[64:65], v[72:73]
  v_pk_fma_f32 v[72:73], v[66:67], v[66:67], v[72:73]
  v_pk_fma_f32 v[72:73], v[68:69], v[68:69], v[72:73]
  v_add_f32 v72, v72, v73
  s_nop 1
  v_add_f32_dpp v72, v72, v72 row_half_mirror row_mask:0xf bank_mask:0xf
  s_nop 1
  v_add_f32_dpp v72, v72, v72 quad_perm:[2,3,0,1] row_mask:0xf bank_mask:0xf
  s_nop 1
  v_add_f32_dpp v72, v72, v72 quad_perm:[1,0,3,2] row_mask:0xf bank_mask:0xf
  v_mov_b32 v73, v72
  s_nop 1
  v_permlane16_swap_b32 v72, v73
  s_nop 1
  v_add_f32 v72, v72, v73
  v_mov_b32 v73, v72
  s_nop 1
  v_permlane32_swap_b32 v72, v73
  s_nop 1
  v_add_f32 v72, v72, v73
  v_mul_f32 v72, s11, v72
  v_cvt_pk_bf16_f32 v72, 0, v72
  v_add_f32 v72, 0x3727c5ac, v72
  v_cvt_pk_bf16_f32 v72, 0, v72
  v_sqrt_f32 v72, v72
  v_cvt_pk_bf16_f32 v70, 0, v70
  v_cvt_pk_bf16_f32 v72, 0, v72
  v_rcp_f32 v74, v72
  s_waitcnt vmcnt(20)
  v_lshlrev_b32 v50, 16, v40
  v_and_b32 v51, 0xffff0000, v40
  v_lshlrev_b32 v52, 16, v41
  v_and_b32 v53, 0xffff0000, v41
  v_lshlrev_b32 v54, 16, v42
  v_and_b32 v55, 0xffff0000, v42
  v_lshlrev_b32 v56, 16, v43
  v_and_b32 v57, 0xffff0000, v43
  v_lshlrev_b32 v58, 16, v44
  v_and_b32 v59, 0xffff0000, v44
  v_lshlrev_b32 v60, 16, v45
  v_and_b32 v61, 0xffff0000, v45
  v_lshlrev_b32 v62, 16, v46
  v_and_b32 v63, 0xffff0000, v46
  v_lshlrev_b32 v64, 16, v47
  v_and_b32 v65, 0xffff0000, v47
  v_lshlrev_b32 v66, 16, v48
  v_and_b32 v67, 0xffff0000, v48
  v_lshlrev_b32 v68, 16, v49
  v_and_b32 v69, 0xffff0000, v49
  v_pk_add_f32 v[50:51], v[50:51], v[70:71] op_sel_hi:[1,0] neg_lo:[0,1] neg_hi:[0,1]
  v_pk_add_f32 v[52:53], v[52:53], v[70:71] op_sel_hi:[1,0] neg_lo:[0,1] neg_hi:[0,1]
  v_pk_add_f32 v[54:55], v[54:55], v[70:71] op_sel_hi:[1,0] neg_lo:[0,1] neg_hi:[0,1]
  v_pk_add_f32 v[56:57], v[56:57], v[70:71] op_sel_hi:[1,0] neg_lo:[0,1] neg_hi:[0,1]
  v_pk_add_f32 v[58:59], v[58:59], v[70:71] op_sel_hi:[1,0] neg_lo:[0,1] neg_hi:[0,1]
  v_pk_add_f32 v[60:61], v[60:61], v[70:71] op_sel_hi:[1,0] neg_lo:[0,1] neg_hi:[0,1]
  v_pk_add_f32 v[62:63], v[62:63], v[70:71] op_sel_hi:[1,0] neg_lo:[0,1] neg_hi:[0,1]
  v_pk_add_f32 v[64:65], v[64:65], v[70:71] op_sel_hi:[1,0] neg_lo:[0,1] neg_hi:[0,1]
  v_pk_add_f32 v[66:67], v[66:67], v[70:71] op_sel_hi:[1,0] neg_lo:[0,1] neg_hi:[0,1]
  v_pk_add_f32 v[68:69], v[68:69], v[70:71] op_sel_hi:[1,0] neg_lo:[0,1] neg_hi:[0,1]
  v_cvt_pk_bf16_f32 v50, 0, v50
  v_cvt_pk_bf16_f32 v51, 0, v51
  v_cvt_pk_bf16_f32 v52, 0, v52
  v_cvt_pk_bf16_f32 v53, 0, v53
  v_cvt_pk_bf16_f32 v54, 0, v54
  v_cvt_pk_bf16_f32 v55, 0, v55
  v_cvt_pk_bf16_f32 v56, 0, v56
  v_cvt_pk_bf16_f32 v57, 0, v57
  v_cvt_pk_bf16_f32 v58, 0, v58
  v_cvt_pk_bf16_f32 v59, 0, v59
  v_cvt_pk_bf16_f32 v60, 0, v60
  v_cvt_pk_bf16_f32 v61, 0, v61
  v_cvt_pk_bf16_f32 v62, 0, v62
  v_cvt_pk_bf16_f32 v63, 0, v63
  v_cvt_pk_bf16_f32 v64, 0, v64
  v_cvt_pk_bf16_f32 v65, 0, v65
  v_cvt_pk_bf16_f32 v66, 0, v66
  v_cvt_pk_bf16_f32 v67, 0, v67
  v_cvt_pk_bf16_f32 v68, 0, v68
  v_cvt_pk_bf16_f32 v69, 0, v69
  v_pk_mul_f32 v[76:77], v[50:51], v[74:75] op_sel_hi:[1,0]
  v_pk_fma_f32 v[50:51], v[76:77], v[72:73], v[50:51] op_sel_hi:[1,0,1] neg_lo:[1,0,0] neg_hi:[1,0,0]
  v_pk_fma_f32 v[50:51], v[50:51], v[74:75], v[76:77] op_sel_hi:[1,0,1]
  v_pk_mul_f32 v[76:77], v[52:53], v[74:75] op_sel_hi:[1,0]
  v_pk_fma_f32 v[52:53], v[76:77], v[72:73], v[52:53] op_sel_hi:[1,0,1] neg_lo:[1,0,0] neg_hi:[1,0,0]
  v_pk_fma_f32 v[52:53], v[52:53], v[74:75], v[76:77] op_sel_hi:[1,0,1]
  v_pk_mul_f32 v[76:77], v[54:55], v[74:75] op_sel_hi:[1,0]
  v_pk_fma_f32 v[54:55], v[76:77], v[72:73], v[54:55] op_sel_hi:[1,0,1] neg_lo:[1,0,0] neg_hi:[1,0,0]
  v_pk_fma_f32 v[54:55], v[54:55], v[74:75], v[76:77] op_sel_hi:[1,0,1]
  v_pk_mul_f32 v[76:77], v[56:57], v[74:75] op_sel_hi:[1,0]
  v_pk_fma_f32 v[56:57], v[76:77], v[72:73], v[56:57] op_sel_hi:[1,0,1] neg_lo:[1,0,0] neg_hi:[1,0,0]
  v_pk_fma_f32 v[56:57], v[56:57], v[74:75], v[76:77] op_sel_hi:[1,0,1]
  v_pk_mul_f32 v[76:77], v[58:59], v[74:75] op_sel_hi:[1,0]
  v_pk_fma_f32 v[58:59], v[76:77], v[72:73], v[58:59] op_sel_hi:[1,0,1] neg_lo:[1,0,0] neg_hi:[1,0,0]
  v_pk_fma_f32 v[58:59], v[58:59], v[74:75], v[76:77] op_sel_hi:[1,0,1]
  v_pk_mul_f32 v[76:77], v[60:61], v[74:75] op_sel_hi:[1,0]
  v_pk_fma_f32 v[60:61], v[76:77], v[72:73], v[60:61] op_sel_hi:[1,0,1] neg_lo:[1,0,0] neg_hi:[1,0,0]
  v_pk_fma_f32 v[60:61], v[60:61], v[74:75], v[76:77] op_sel_hi:[1,0,1]
  v_pk_mul_f32 v[76:77], v[62:63], v[74:75] op_sel_hi:[1,0]
  v_pk_fma_f32 v[62:63], v[76:77], v[72:73], v[62:63] op_sel_hi:[1,0,1] neg_lo:[1,0,0] neg_hi:[1,0,0]
  v_pk_fma_f32 v[62:63], v[62:63], v[74:75], v[76:77] op_sel_hi:[1,0,1]
  v_pk_mul_f32 v[76:77], v[64:65], v[74:75] op_sel_hi:[1,0]
  v_pk_fma_f32 v[64:65], v[76:77], v[72:73], v[64:65] op_sel_hi:[1,0,1] neg_lo:[1,0,0] neg_hi:[1,0,0]
  v_pk_fma_f32 v[64:65], v[64:65], v[74:75], v[76:77] op_sel_hi:[1,0,1]
  v_pk_mul_f32 v[76:77], v[66:67], v[74:75] op_sel_hi:[1,0]
  v_pk_fma_f32 v[66:67], v[76:77], v[72:73], v[66:67] op_sel_hi:[1,0,1] neg_lo:[1,0,0] neg_hi:[1,0,0]
  v_pk_fma_f32 v[66:67], v[66:67], v[74:75], v[76:77] op_sel_hi:[1,0,1]
  v_pk_mul_f32 v[76:77], v[68:69], v[74:75] op_sel_hi:[1,0]
  v_pk_fma_f32 v[68:69], v[76:77], v[72:73], v[68:69] op_sel_hi:[1,0,1] neg_lo:[1,0,0] neg_hi:[1,0,0]
  v_pk_fma_f32 v[68:69], v[68:69], v[74:75], v[76:77] op_sel_hi:[1,0,1]
  v_cvt_pk_bf16_f32 v50, v50, v50
  v_cvt_pk_bf16_f32 v51, v51, v51
  v_cvt_pk_bf16_f32 v52, v52, v52
  v_cvt_pk_bf16_f32 v53, v53, v53
  v_cvt_pk_bf16_f32 v54, v54, v54
  v_cvt_pk_bf16_f32 v55, v55, v55
  v_cvt_pk_bf16_f32 v56, v56, v56
  v_cvt_pk_bf16_f32 v57, v57, v57
  v_cvt_pk_bf16_f32 v58, v58, v58
  v_cvt_pk_bf16_f32 v59, v59, v59
  v_cvt_pk_bf16_f32 v60, v60, v60
  v_cvt_pk_bf16_f32 v61, v61, v61
  v_cvt_pk_bf16_f32 v62, v62, v62
  v_cvt_pk_bf16_f32 v63, v63, v63
  v_cvt_pk_bf16_f32 v64, v64, v64
  v_cvt_pk_bf16_f32 v65, v65, v65
  v_cvt_pk_bf16_f32 v66, v66, v66
  v_cvt_pk_bf16_f32 v67, v67, v67
  v_cvt_pk_bf16_f32 v68, v68, v68
  v_cvt_pk_bf16_f32 v69, v69, v69
  v_and_b32 v36, v50, v6
  v_and_b32 v37, v50, v7
  v_and_b32 v38, v50, v8
  v_and_b32 v39, v50, v9
  s_waitcnt vmcnt(19)
  s_nop 0
  v_mfma_f32_16x16x32_bf16 v[32:35], v[36:39], v[96:99], 0
  v_and_b32 v40, v51, v6
  v_and_b32 v41, v51, v7
  v_and_b32 v42, v51, v8
  v_and_b32 v43, v51, v9
  s_waitcnt vmcnt(18)
  s_nop 0
  v_mfma_f32_16x16x32_bf16 v[32:35], v[40:43], v[100:103], v[32:35]
  v_and_b32 v36, v52, v6
  v_and_b32 v37, v52, v7
  v_and_b32 v38, v52, v8
  v_and_b32 v39, v52, v9
  s_waitcnt vmcnt(17)
  s_nop 0
  v_mfma_f32_16x16x32_bf16 v[32:35], v[36:39], v[104:107], v[32:35]
  v_and_b32 v40, v53, v6
  v_and_b32 v41, v53, v7
  v_and_b32 v42, v53, v8
  v_and_b32 v43, v53, v9
  s_waitcnt vmcnt(16)
  s_nop 0
  v_mfma_f32_16x16x32_bf16 v[32:35], v[40:43], v[108:111], v[32:35]
  v_and_b32 v36, v54, v6
  v_and_b32 v37, v54, v7
  v_and_b32 v38, v54, v8
  v_and_b32 v39, v54, v9
  s_waitcnt vmcnt(15)
  s_nop 0
  v_mfma_f32_16x16x32_bf16 v[32:35], v[36:39], v[112:115], v[32:35]
  v_and_b32 v40, v55, v6
  v_and_b32 v41, v55, v7
  v_and_b32 v42, v55, v8
  v_and_b32 v43, v55, v9
  s_waitcnt vmcnt(14)
  s_nop 0
  v_mfma_f32_16x16x32_bf16 v[32:35], v[40:43], v[116:119], v[32:35]
  v_and_b32 v36, v56, v6
  v_and_b32 v37, v56, v7
  v_and_b32 v38, v56, v8
  v_and_b32 v39, v56, v9
  s_waitcnt vmcnt(13)
  s_nop 0
  v_mfma_f32_16x16x32_bf16 v[32:35], v[36:39], v[120:123], v[32:35]
  v_and_b32 v40, v57, v6
  v_and_b32 v41, v57, v7
  v_and_b32 v42, v57, v8
  v_and_b32 v43, v57, v9
  s_waitcnt vmcnt(12)
  s_nop 0
  v_mfma_f32_16x16x32_bf16 v[32:35], v[40:43], v[124:127], v[32:35]
  v_and_b32 v36, v58, v6
  v_and_b32 v37, v58, v7
  v_and_b32 v38, v58, v8
  v_and_b32 v39, v58, v9
  s_waitcnt vmcnt(11)
  s_nop 0
  v_mfma_f32_16x16x32_bf16 v[32:35], v[36:39], v[128:131], v[32:35]
  v_and_b32 v40, v59, v6
  v_and_b32 v41, v59, v7
  v_and_b32 v42, v59, v8
  v_and_b32 v43, v59, v9
  s_waitcnt vmcnt(10)
  s_nop 0
  v_mfma_f32_16x16x32_bf16 v[32:35], v[40:43], v[132:135], v[32:35]
  v_and_b32 v36, v60, v6
  v_and_b32 v37, v60, v7
  v_and_b32 v38, v60, v8
  v_and_b32 v39, v60, v9
  s_waitcnt vmcnt(9)
  s_nop 0
  v_mfma_f32_16x16x32_bf16 v[32:35], v[36:39], v[136:139], v[32:35]
  v_and_b32 v40, v61, v6
  v_and_b32 v41, v61, v7
  v_and_b32 v42, v61, v8
  v_and_b32 v43, v61, v9
  s_waitcnt vmcnt(8)
  s_nop 0
  v_mfma_f32_16x16x32_bf16 v[32:35], v[40:43], v[140:143], v[32:35]
  v_and_b32 v36, v62, v6
  v_and_b32 v37, v62, v7
  v_and_b32 v38, v62, v8
  v_and_b32 v39, v62, v9
  s_waitcnt vmcnt(7)
  s_nop 0
  v_mfma_f32_16x16x32_bf16 v[32:35], v[36:39], v[144:147], v[32:35]
  v_and_b32 v40, v63, v6
  v_and_b32 v41, v63, v7
  v_and_b32 v42, v63, v8
  v_and_b32 v43, v63, v9
  s_waitcnt vmcnt(6)
  s_nop 0
  v_mfma_f32_16x16x32_bf16 v[32:35], v[40:43], v[148:151], v[32:35]
  v_and_b32 v36, v64, v6
  v_and_b32 v37, v64, v7
  v_and_b32 v38, v64, v8
  v_and_b32 v39, v64, v9
  s_waitcnt vmcnt(5)
  s_nop 0
  v_mfma_f32_16x16x32_bf16 v[32:35], v[36:39], v[152:155], v[32:35]
  v_and_b32 v40, v65, v6
  v_and_b32 v41, v65, v7
  v_and_b32 v42, v65, v8
  v_and_b32 v43, v65, v9
  s_waitcnt vmcnt(4)
  s_nop 0
  v_mfma_f32_16x16x32_bf16 v[32:35], v[40:43], v[156:159], v[32:35]
  v_and_b32 v36, v66, v6
  v_and_b32 v37, v66, v7
  v_and_b32 v38, v66, v8
  v_and_b32 v39, v66, v9
  s_waitcnt vmcnt(3)
  s_nop 0
  v_mfma_f32_16x16x32_bf16 v[32:35], v[36:39], v[160:163], v[32:35]
  v_and_b32 v40, v67, v6
  v_and_b32 v41, v67, v7
  v_and_b32 v42, v67, v8
  v_and_b32 v43, v67, v9
  s_waitcnt vmcnt(2)
  s_nop 0
  v_mfma_f32_16x16x32_bf16 v[32:35], v[40:43], v[164:167], v[32:35]
  v_and_b32 v36, v68, v6
  v_and_b32 v37, v68, v7
  v_and_b32 v38, v68, v8
  v_and_b32 v39, v68, v9
  s_waitcnt vmcnt(1)
  s_nop 0
  v_mfma_f32_16x16x32_bf16 v[32:35], v[36:39], v[168:171], v[32:35]
  v_and_b32 v40, v69, v6
  v_and_b32 v41, v69, v7
  v_and_b32 v42, v69, v8
  v_and_b32 v43, v69, v9
  s_waitcnt vmcnt(0)
  s_nop 0
  v_mfma_f32_16x16x32_bf16 v[32:35], v[40:43], v[172:175], v[32:35]
  s_lshl_b32 s13, s64, 3
  s_add_u32 s13, s13, s65
  s_lshl_b32 s13, s13, 10
  s_nop 4
  v_and_or_b32 v32, v32, s60, v92
  v_and_or_b32 v33, v33, s60, v92
  v_and_or_b32 v34, v34, s60, v92
  v_and_or_b32 v35, v35, s60, v92
  buffer_store_dwordx4 v[32:35], v29, s[52:55], s13 offen sc1
L_bar1a:
  s_barrier
  s_cmp_eq_u32 s10, 0
  s_cbranch_scc0 L_bar1
  v_lshrrev_b32 v36, 5, v0
  v_lshlrev_b32 v36, 10, v36
  v_and_b32 v37, 31, v0
  v_lshl_add_u32 v36, v37, 4, v36
  s_lshl_b32 s13, s6, 13
  s_lshl_b32 s11, s7, 9
  s_add_u32 s13, s13, s11
  s_add_u32 s14, s13, 4096
  s_mov_b32 s12, 131072
L_qg:
  buffer_load_dwordx4 v[40:43], v36, s[52:55], s13 offen offset:0 sc1
  buffer_load_dwordx4 v[44:47], v36, s[52:55], s13 offen offset:2048 sc1
  buffer_load_dwordx4 v[48:51], v36, s[52:55], s14 offen offset:0 sc1
  buffer_load_dwordx4 v[52:55], v36, s[52:55], s14 offen offset:2048 sc1
  s_waitcnt vmcnt(0)
  v_xor_b32 v40, s43, v40
  v_xor_b32 v41, s43, v41
  v_xor_b32 v42, s43, v42
  v_xor_b32 v43, s43, v43
  v_xor_b32 v44, s43, v44
  v_xor_b32 v45, s43, v45
  v_xor_b32 v46, s43, v46
  v_xor_b32 v47, s43, v47
  v_xor_b32 v48, s43, v48
  v_xor_b32 v49, s43, v49
  v_xor_b32 v50, s43, v50
  v_xor_b32 v51, s43, v51
  v_xor_b32 v52, s43, v52
  v_xor_b32 v53, s43, v53
  v_xor_b32 v54, s43, v54
  v_xor_b32 v55, s43, v55
  v_or3_b32 v37, v40, v41, v42
  v_or3_b32 v37, v37, v43, v44
  v_or3_b32 v37, v37, v45, v46
  v_or3_b32 v37, v37, v47, v48
  v_or3_b32 v37, v37, v49, v50
  v_or3_b32 v37, v37, v51, v52
  v_or3_b32 v37, v37, v53, v54
  v_or_b32 v37, v37, v55
  v_and_b32 v37, 0xff, v37
  v_cmp_ne_u32 vcc, 0, v37
  s_sub_u32 s12, s12, 1
  s_cbranch_scc1 L_qg_ok
  s_cbranch_vccnz L_qg
L_qg_ok:
  v_add_f32 v40, v40, v44
  v_add_f32 v48, v48, v52
  v_add_f32 v41, v41, v45
  v_add_f32 v49, v49, v53
  v_add_f32 v42, v42, v46
  v_add_f32 v50, v50, v54
  v_add_f32 v43, v43, v47
  v_add_f32 v51, v51, v55
  v_add_f32 v40, v40, v48
  v_add_f32 v41, v41, v49
  v_add_f32 v42, v42, v50
  v_add_f32 v43, v43, v51
  ds_write_b128 v23, v[40:43] offset:0
  s_waitcnt lgkmcnt(0)
L_bar1:
  s_barrier
  s_mul_i32 s11, s6, 163840
  s_add_u32 s64, s24, s11
  s_addc_u32 s65, s25, 0
  s_mov_b32 s66, 163840
  s_mov_b32 s67, 0x20000
  v_mul_u32_u24 v93, 10240, v3
  v_lshl_add_u32 v93, v4, 4, v93
  v_cmp_gt_u32 vcc, 10, v4
  s_mul_i32 s61, s10, 40960
  s_mul_i32 s12, s5, 160
  v_cndmask_b32 v93, v22, v93, vcc
  s_add_u32 s61, s61, s12
  buffer_load_dwordx4 v[192:195], v93, s[64:67], s61 offen offset:0 nt
  buffer_load_dwordx4 v[196:199], v93, s[64:67], s61 offen offset:1280 nt
  v_mul_u32_u24 v94, 20480, v3
  v_lshl_add_u32 v94, v4, 4, v94
  s_mul_i32 s62, s56, 81920
  s_lshl_b32 s12, s57, 8
  s_add_u32 s62, s62, s12
  s_cmp_ge_u32 s2, 216
  s_cselect_b32 s11, 1, 0
  s_cmp_eq_u32 s10, 2
  s_cselect_b32 s59, s11, 0
  s_sub_u32 s11, s2, 112
  s_cmp_lt_u32 s11, 135
  s_cselect_b32 s11, 1, 0
  s_cmp_eq_u32 s10, 1
  s_cselect_b32 s63, s11, 0
  s_cmp_lg_u32 s10, 2
  s_cbranch_scc1 L_warmed
  s_mov_b32 s71, 1
  s_branch L_drain
L_warmed:
  s_cmp_lg_u32 s59, 0
  s_cbranch_scc1 L_cons
  s_cmp_eq_u32 s63, 0
  s_cbranch_scc1 L_bark
  s_mov_b32 s48, s30
  s_mov_b32 s49, s31
  s_mov_b32 s50, 3456
  s_mov_b32 s51, 0x20000
  v_lshlrev_b32 v21, 5, v3
  s_lshl_b32 s11, s56, 7
  buffer_load_dwordx4 v[80:83], v21, s[48:51], s11 offen
  buffer_load_dwordx4 v[84:87], v21, s[48:51], s11 offen offset:16
  v_and_b32 v36, 7, v0
  v_lshlrev_b32 v36, 10, v36
  v_lshl_add_u32 v36, v5, 9, v36
  v_lshl_add_u32 v36, v3, 5, v36
  s_lshr_b32 s13, s56, 1
  s_add_u32 s13, s13, 32
  s_lshl_b32 s13, s13, 13
  s_and_b32 s11, s56, 1
  s_lshl_b32 s11, s11, 7
  s_add_u32 s13, s13, s11
  s_mov_b32 s12, 131072
L_hg:
  buffer_load_dwordx4 v[48:51], v36, s[52:55], s13 offen offset:0 sc1
  buffer_load_dwordx4 v[52:55], v36, s[52:55], s13 offen offset:256 sc1
  buffer_load_dwordx4 v[56:59], v36, s[52:55], s13 offen offset:16 sc1
  buffer_load_dwordx4 v[60:63], v36, s[52:55], s13 offen offset:272 sc1
  s_waitcnt vmcnt(0)
  v_xor_b32 v48, s43, v48
  v_xor_b32 v49, s43, v49
  v_xor_b32 v50, s43, v50
  v_xor_b32 v51, s43, v51
  v_xor_b32 v52, s43, v52
  v_xor_b32 v53, s43, v53
  v_xor_b32 v54, s43, v54
  v_xor_b32 v55, s43, v55
  v_xor_b32 v56, s43, v56
  v_xor_b32 v57, s43, v57
  v_xor_b32 v58, s43, v58
  v_xor_b32 v59, s43, v59
  v_xor_b32 v60, s43, v60
  v_xor_b32 v61, s43, v61
  v_xor_b32 v62, s43, v62
  v_xor_b32 v63, s43, v63
  v_or3_b32 v37, v48, v49, v50
  v_or3_b32 v37, v37, v51, v52
  v_or3_b32 v37, v37, v53, v54
  v_or3_b32 v37, v37, v55, v56
  v_or3_b32 v37, v37, v57, v58
  v_or3_b32 v37, v37, v59, v60
  v_or3_b32 v37, v37, v61, v62
  v_or_b32 v37, v37, v63
  v_and_b32 v37, 0xff, v37
  v_cmp_ne_u32 vcc, 0, v37
  s_sub_u32 s12, s12, 1
  s_cbranch_scc1 L_hg_ok
  s_cbranch_vccz L_hg_ok
  s_sleep 8
  s_branch L_hg
L_hg_ok:
  v_add_f32_dpp v48, v48, v48 row_half_mirror row_mask:0xf bank_mask:0xf
  v_add_f32_dpp v49, v49, v49 row_half_mirror row_mask:0xf bank_mask:0xf
  v_add_f32_dpp v50, v50, v50 row_half_mirror row_mask:0xf bank_mask:0xf
  v_add_f32_dpp v51, v51, v51 row_half_mirror row_mask:0xf bank_mask:0xf
  v_add_f32_dpp v52, v52, v52 row_half_mirror row_mask:0xf bank_mask:0xf
  v_add_f32_dpp v53, v53, v53 row_half_mirror row_mask:0xf bank_mask:0xf
  v_add_f32_dpp v54, v54, v54 row_half_mirror row_mask:0xf bank_mask:0xf
  v_add_f32_dpp v55, v55, v55 row_half_mirror row_mask:0xf bank_mask:0xf
  v_add_f32_dpp v56, v56, v56 row_half_mirror row_mask:0xf bank_mask:0xf
  v_add_f32_dpp v57, v57, v57 row_half_mirror row_mask:0xf bank_mask:0xf
  v_add_f32_dpp v58, v58, v58 row_half_mirror row_mask:0xf bank_mask:0xf
  v_add_f32_dpp v59, v59, v59 row_half_mirror row_mask:0xf bank_mask:0xf
  v_add_f32_dpp v60, v60, v60 row_half_mirror row_mask:0xf bank_mask:0xf
  v_add_f32_dpp v61, v61, v61 row_half_mirror row_mask:0xf bank_mask:0xf
  v_add_f32_dpp v62, v62, v62 row_half_mirror row_mask:0xf bank_mask:0xf
  v_add_f32_dpp v63, v63, v63 row_half_mirror row_mask:0xf bank_mask:0xf
  v_add_f32_dpp v48, v48, v48 quad_perm:[2,3,0,1] row_mask:0xf bank_mask:0xf
  v_add_f32_dpp v49, v49, v49 quad_perm:[2,3,0,1] row_mask:0xf bank_mask:0xf
  v_add_f32_dpp v50, v50, v50 quad_perm:[2,3,0,1] row_mask:0xf bank_mask:0xf
  v_add_f32_dpp v51, v51, v51 quad_perm:[2,3,0,1] row_mask:0xf bank_mask:0xf
  v_add_f32_dpp v52, v52, v52 quad_perm:[2,3,0,1] row_mask:0xf bank_mask:0xf
  v_add_f32_dpp v53, v53, v53 quad_perm:[2,3,0,1] row_mask:0xf bank_mask:0xf
  v_add_f32_dpp v54, v54, v54 quad_perm:[2,3,0,1] row_mask:0xf bank_mask:0xf
  v_add_f32_dpp v55, v55, v55 quad_perm:[2,3,0,1] row_mask:0xf bank_mask:0xf
  v_add_f32_dpp v56, v56, v56 quad_perm:[2,3,0,1] row_mask:0xf bank_mask:0xf
  v_add_f32_dpp v57, v57, v57 quad_perm:[2,3,0,1] row_mask:0xf bank_mask:0xf
  v_add_f32_dpp v58, v58, v58 quad_perm:[2,3,0,1] row_mask:0xf bank_mask:0xf
  v_add_f32_dpp v59, v59, v59 quad_perm:[2,3,0,1] row_mask:0xf bank_mask:0xf
  v_add_f32_dpp v60, v60, v60 quad_perm:[2,3,0,1] row_mask:0xf bank_mask:0xf
  v_add_f32_dpp v61, v61, v61 quad_perm:[2,3,0,1] row_mask:0xf bank_mask:0xf
  v_add_f32_dpp v62, v62, v62 quad_perm:[2,3,0,1] row_mask:0xf bank_mask:0xf
  v_add_f32_dpp v63, v63, v63 quad_perm:[2,3,0,1] row_mask:0xf bank_mask:0xf
  v_add_f32_dpp v48, v48, v48 quad_perm:[1,0,3,2] row_mask:0xf bank_mask:0xf
  v_add_f32_dpp v49, v49, v49 quad_perm:[1,0,3,2] row_mask:0xf bank_mask:0xf
  v_add_f32_dpp v50, v50, v50 quad_perm:[1,0,3,2] row_mask:0xf bank_mask:0xf
  v_add_f32_dpp v51, v51, v51 quad_perm:[1,0,3,2] row_mask:0xf bank_mask:0xf
  v_add_f32_dpp v52, v52, v52 quad_perm:[1,0,3,2] row_mask:0xf bank_mask:0xf
  v_add_f32_dpp v53, v53, v53 quad_perm:[1,0,3,2] row_mask:0xf bank_mask:0xf
  v_add_f32_dpp v54, v54, v54 quad_perm:[1,0,3,2] row_mask:0xf bank_mask:0xf
  v_add_f32_dpp v55, v55, v55 quad_perm:[1,0,3,2] row_mask:0xf bank_mask:0xf
  v_add_f32_dpp v56, v56, v56 quad_perm:[1,0,3,2] row_mask:0xf bank_mask:0xf
  v_add_f32_dpp v57, v57, v57 quad_perm:[1,0,3,2] row_mask:0xf bank_mask:0xf
  v_add_f32_dpp v58, v58, v58 quad_perm:[1,0,3,2] row_mask:0xf bank_mask:0xf
  v_add_f32_dpp v59, v59, v59 quad_perm:[1,0,3,2] row_mask:0xf bank_mask:0xf
  v_add_f32_dpp v60, v60, v60 quad_perm:[1,0,3,2] row_mask:0xf bank_mask:0xf
  v_add_f32_dpp v61, v61, v61 quad_perm:[1,0,3,2] row_mask:0xf bank_mask:0xf
  v_add_f32_dpp v62, v62, v62 quad_perm:[1,0,3,2] row_mask:0xf bank_mask:0xf
  v_add_f32_dpp v63, v63, v63 quad_perm:[1,0,3,2] row_mask:0xf bank_mask:0xf
  v_lshlrev_b32 v64, 16, v80
  v_and_b32 v65, 0xffff0000, v80
  v_lshlrev_b32 v66, 16, v81
  v_and_b32 v67, 0xffff0000, v81
  v_lshlrev_b32 v68, 16, v82
  v_and_b32 v69, 0xffff0000, v82
  v_lshlrev_b32 v70, 16, v83
  v_and_b32 v71, 0xffff0000, v83
  v_lshlrev_b32 v72, 16, v84
  v_and_b32 v73, 0xffff0000, v84
  v_lshlrev_b32 v74, 16, v85
  v_and_b32 v75, 0xffff0000, v85
  v_lshlrev_b32 v76, 16, v86
  v_and_b32 v77, 0xffff0000, v86
  v_lshlrev_b32 v78, 16, v87
  v_and_b32 v79, 0xffff0000, v87
  v_cvt_pk_bf16_f32 v48, 0, v48
  v_add_f32 v48, v48, v64
  v_cvt_pk_bf16_f32 v48, 0, v48
  v_cmp_lt_f32 vcc, 0, v48
  s_nop 1
  v_cndmask_b32 v48, 0, v48, vcc
  v_mul_f32 v48, v48, v48
  v_cvt_pk_bf16_f32 v48, v48, v48
  v_cvt_pk_bf16_f32 v49, 0, v49
  v_add_f32 v49, v49, v65
  v_cvt_pk_bf16_f32 v49, 0, v49
  v_cmp_lt_f32 vcc, 0, v49
  s_nop 1
  v_cndmask_b32 v49, 0, v49, vcc
  v_mul_f32 v49, v49, v49
  v_cvt_pk_bf16_f32 v49, v49, v49
  v_cvt_pk_bf16_f32 v50, 0, v50
  v_add_f32 v50, v50, v66
  v_cvt_pk_bf16_f32 v50, 0, v50
  v_cmp_lt_f32 vcc, 0, v50
  s_nop 1
  v_cndmask_b32 v50, 0, v50, vcc
  v_mul_f32 v50, v50, v50
  v_cvt_pk_bf16_f32 v50, v50, v50
  v_cvt_pk_bf16_f32 v51, 0, v51
  v_add_f32 v51, v51, v67
  v_cvt_pk_bf16_f32 v51, 0, v51
  v_cmp_lt_f32 vcc, 0, v51
  s_nop 1
  v_cndmask_b32 v51, 0, v51, vcc
  v_mul_f32 v51, v51, v51
  v_cvt_pk_bf16_f32 v51, v51, v51
  v_cvt_pk_bf16_f32 v52, 0, v52
  v_add_f32 v52, v52, v68
  v_cvt_pk_bf16_f32 v52, 0, v52
  v_cmp_lt_f32 vcc, 0, v52
  s_nop 1
  v_cndmask_b32 v52, 0, v52, vcc
  v_mul_f32 v52, v52, v52
  v_cvt_pk_bf16_f32 v52, v52, v52
  v_cvt_pk_bf16_f32 v53, 0, v53
  v_add_f32 v53, v53, v69
  v_cvt_pk_bf16_f32 v53, 0, v53
  v_cmp_lt_f32 vcc, 0, v53
  s_nop 1
  v_cndmask_b32 v53, 0, v53, vcc
  v_mul_f32 v53, v53, v53
  v_cvt_pk_bf16_f32 v53, v53, v53
  v_cvt_pk_bf16_f32 v54, 0, v54
  v_add_f32 v54, v54, v70
  v_cvt_pk_bf16_f32 v54, 0, v54
  v_cmp_lt_f32 vcc, 0, v54
  s_nop 1
  v_cndmask_b32 v54, 0, v54, vcc
  v_mul_f32 v54, v54, v54
  v_cvt_pk_bf16_f32 v54, v54, v54
  v_cvt_pk_bf16_f32 v55, 0, v55
  v_add_f32 v55, v55, v71
  v_cvt_pk_bf16_f32 v55, 0, v55
  v_cmp_lt_f32 vcc, 0, v55
  s_nop 1
  v_cndmask_b32 v55, 0, v55, vcc
  v_mul_f32 v55, v55, v55
  v_cvt_pk_bf16_f32 v55, v55, v55
  v_cvt_pk_bf16_f32 v56, 0, v56
  v_add_f32 v56, v56, v72
  v_cvt_pk_bf16_f32 v56, 0, v56
  v_cmp_lt_f32 vcc, 0, v56
  s_nop 1
  v_cndmask_b32 v56, 0, v56, vcc
  v_mul_f32 v56, v56, v56
  v_cvt_pk_bf16_f32 v56, v56, v56
  v_cvt_pk_bf16_f32 v57, 0, v57
  v_add_f32 v57, v57, v73
  v_cvt_pk_bf16_f32 v57, 0, v57
  v_cmp_lt_f32 vcc, 0, v57
  s_nop 1
  v_cndmask_b32 v57, 0, v57, vcc
  v_mul_f32 v57, v57, v57
  v_cvt_pk_bf16_f32 v57, v57, v57
  v_cvt_pk_bf16_f32 v58, 0, v58
  v_add_f32 v58, v58, v74
  v_cvt_pk_bf16_f32 v58, 0, v58
  v_cmp_lt_f32 vcc, 0, v58
  s_nop 1
  v_cndmask_b32 v58, 0, v58, vcc
  v_mul_f32 v58, v58, v58
  v_cvt_pk_bf16_f32 v58, v58, v58
  v_cvt_pk_bf16_f32 v59, 0, v59
  v_add_f32 v59, v59, v75
  v_cvt_pk_bf16_f32 v59, 0, v59
  v_cmp_lt_f32 vcc, 0, v59
  s_nop 1
  v_cndmask_b32 v59, 0, v59, vcc
  v_mul_f32 v59, v59, v59
  v_cvt_pk_bf16_f32 v59, v59, v59
  v_cvt_pk_bf16_f32 v60, 0, v60
  v_add_f32 v60, v60, v76
  v_cvt_pk_bf16_f32 v60, 0, v60
  v_cmp_lt_f32 vcc, 0, v60
  s_nop 1
  v_cndmask_b32 v60, 0, v60, vcc
  v_mul_f32 v60, v60, v60
  v_cvt_pk_bf16_f32 v60, v60, v60
  v_cvt_pk_bf16_f32 v61, 0, v61
  v_add_f32 v61, v61, v77
  v_cvt_pk_bf16_f32 v61, 0, v61
  v_cmp_lt_f32 vcc, 0, v61
  s_nop 1
  v_cndmask_b32 v61, 0, v61, vcc
  v_mul_f32 v61, v61, v61
  v_cvt_pk_bf16_f32 v61, v61, v61
  v_cvt_pk_bf16_f32 v62, 0, v62
  v_add_f32 v62, v62, v78
  v_cvt_pk_bf16_f32 v62, 0, v62
  v_cmp_lt_f32 vcc, 0, v62
  s_nop 1
  v_cndmask_b32 v62, 0, v62, vcc
  v_mul_f32 v62, v62, v62
  v_cvt_pk_bf16_f32 v62, v62, v62
  v_cvt_pk_bf16_f32 v63, 0, v63
  v_add_f32 v63, v63, v79
  v_cvt_pk_bf16_f32 v63, 0, v63
  v_cmp_lt_f32 vcc, 0, v63
  s_nop 1
  v_cndmask_b32 v63, 0, v63, vcc
  v_mul_f32 v63, v63, v63
  v_cvt_pk_bf16_f32 v63, v63, v63
  v_lshlrev_b32 v36, 2, v29
  ds_write_b128 v36, v[48:51] offset:8256
  ds_write_b128 v36, v[52:55] offset:8272
  ds_write_b128 v36, v[56:59] offset:8288
  ds_write_b128 v36, v[60:63] offset:8304
  s_waitcnt lgkmcnt(0)
  s_branch L_bark
L_cons:
  s_mov_b32 s44, s16
  s_mov_b32 s45, s17
  s_mov_b32 s46, 2560
  s_mov_b32 s47, 0x20000
  s_mov_b32 s48, s34
  s_mov_b32 s49, s35
  s_mov_b32 s50, 1280
  s_mov_b32 s51, 0x20000
  s_sub_u32 s15, s2, 216
  v_and_b32 v36, 3, v0
  v_lshl_add_u32 v36, v36, 2, v3
  s_lshl_b32 s11, s15, 4
  v_add_u32 v36, s11, v36
  v_lshlrev_b32 v36, 1, v36
  v_bfe_u32 v88, v0, 2, 1
  v_mul_u32_u24 v88, 1280, v88
  v_add_u32 v88, v88, v36
  buffer_load_ushort v90, v88, s[44:47], 0 offen
  buffer_load_ushort v91, v36, s[48:51], 0 offen
  s_waitcnt vmcnt(0)
  v_lshlrev_b32 v91, 16, v91
  v_lshlrev_b32 v90, 16, v90
L_bark:
  s_mov_b32 s44, s36
  s_mov_b32 s45, s37
  s_mov_b32 s46, 2560
  s_mov_b32 s47, 0x20000
  s_mov_b32 s48, s32
  s_mov_b32 s49, s33
  s_mov_b32 s50, 2211840
  s_mov_b32 s51, 0x20000
  v_and_b32 v19, 3, v0
  v_lshl_add_u32 v19, v5, 2, v19
  v_mul_u32_u24 v95, 640, v19
  v_lshl_add_u32 v20, v3, 5, v95
  v_and_b32 v18, 4, v0
  v_lshl_add_u32 v20, v18, 2, v20
  s_lshl_b32 s11, s10, 7
  v_add_u32 v20, s11, v20
  s_mul_i32 s13, s6, 5120
  s_add_u32 s13, s13, 376832
  v_lshlrev_b32 v19, 4, v19
  v_add_u32 v19, 0x1000, v19
  s_lshl_b32 s11, s10, 10
  v_add_u32 v18, s11, v29
  s_mul_i32 s68, s6, 4352
  s_add_u32 s68, s68, 540672
  v_lshrrev_b32 v17, 1, v0
  v_lshlrev_b32 v17, 8, v17
  v_and_b32 v16, 1, v0
  v_lshl_add_u32 v17, v16, 6, v17
  s_lshl_b32 s11, s7, 3
  s_add_u32 s11, s11, s8
  s_lshl_b32 s11, s11, 4
  v_add_u32 v17, s11, v17
  s_lshl_b32 s11, s5, 4
  s_add_u32 s11, s11, 0x1000
  v_cmp_gt_u32 vcc, 32, v0
  v_mov_b32 v16, s11
  s_nop 0
  v_cndmask_b32 v17, v16, v17, vcc
  v_cmp_gt_u32 vcc, 33, v0
  s_nop 1
  v_cndmask_b32 v17, v22, v17, vcc
  v_mov_b32 v21, 0
  s_lshl_b32 s11, s10, 10
  v_add_u32 v31, s11, v23
  s_sub_u32 s15, s2, 216
  s_lshl_b32 s15, s15, 12
  s_add_u32 s14, s15, 843776
  s_add_u32 s15, s15, 679936
  v_cmp_gt_u32 vcc, 24, v0
  s_mov_b32 s12, 131072
  s_nop 0
  v_cndmask_b32 v89, v22, v29, vcc
  v_cndmask_b32 v30, v92, 0, vcc
  s_barrier
  s_cmp_eq_u32 s10, 0
  s_cbranch_scc0 L_bard
  ds_read_b128 v[68:71], v21 offset:1024
  ds_read_b128 v[72:75], v21 offset:1040
  s_waitcnt lgkmcnt(0)
  v_max3_f32 v48, v68, v70, v72
  v_max_f32 v48, v48, v74
  v_sub_f32 v64, v68, v48
  v_sub_f32 v65, v70, v48
  v_sub_f32 v66, v72, v48
  v_sub_f32 v67, v74, v48
  v_exp_f32 v64, v64
  v_exp_f32 v65, v65
  v_exp_f32 v66, v66
  v_exp_f32 v67, v67
  v_mov_b32 v49, s42
  v_mov_b32 v51, s42
  v_mul_f32 v50, v64, v69
  v_fmac_f32 v50, v65, v71
  v_fmac_f32 v50, v66, v73
  v_fmac_f32 v50, v67, v75
L_bard:
  s_barrier
  buffer_load_dwordx4 v[200:203], v93, s[64:67], s61 offen offset:2560 nt
  s_add_u32 s61, s61, 3840
  buffer_load_dwordx4 v[204:207], v93, s[64:67], s61 offen offset:0 nt
  buffer_load_dwordx4 v[208:211], v93, s[64:67], s61 offen offset:1280 nt
  buffer_load_dwordx4 v[212:215], v93, s[64:67], s61 offen offset:2560 nt
  s_add_u32 s61, s61, 3840
  buffer_load_dwordx4 v[216:219], v93, s[64:67], s61 offen offset:0 nt
  buffer_load_dwordx4 v[220:223], v93, s[64:67], s61 offen offset:1280 nt
L_bar2:
  s_barrier
  s_cmp_eq_u32 s10, 0
  s_cbranch_scc0 L_nop
  s_mov_b32 exec_hi, 0
  ds_read_b128 v[48:51], v29 offset:1088
  ds_read_b128 v[52:55], v29 offset:1600
  ds_read_b128 v[56:59], v29 offset:2112
  ds_read_b128 v[60:63], v29 offset:2624
  s_waitcnt lgkmcnt(3)
  v_mul_f32 v48, v64, v48
  v_mul_f32 v49, v64, v49
  v_mul_f32 v50, v64, v50
  v_mul_f32 v51, v64, v51
  s_waitcnt lgkmcnt(2)
  v_fmac_f32 v48, v65, v52
  v_fmac_f32 v49, v65, v53
  v_fmac_f32 v50, v65, v54
  v_fmac_f32 v51, v65, v55
  s_waitcnt lgkmcnt(1)
  v_fmac_f32 v48, v66, v56
  v_fmac_f32 v49, v66, v57
  v_fmac_f32 v50, v66, v58
  v_fmac_f32 v51, v66, v59
  s_waitcnt lgkmcnt(0)
  v_fmac_f32 v48, v67, v60
  v_fmac_f32 v49, v67, v61
  v_fmac_f32 v50, v67, v62
  v_fmac_f32 v51, v67, v63
  v_and_or_b32 v48, v48, s60, v92
  v_and_or_b32 v49, v49, s60, v92
  v_and_or_b32 v50, v50, s60, v92
  v_and_or_b32 v51, v51, s60, v92
  s_mov_b64 exec, -1
  buffer_store_dwordx4 v[48:51], v17, s[52:55], s68 offen
L_nop:
  s_barrier
  s_branch L_og
L_og_safe:
  s_cmp_eq_u32 s10, 0
  s_cbranch_scc0 L_og_safe2
  buffer_store_dwordx4 v[48:51], v28, s[52:55], s70 offen sc1
L_og_safe2:
  buffer_load_dwordx4 v[68:71], v95, s[52:55], s13 offen offset:512 sc1
  buffer_load_dwordx4 v[40:43], v20, s[52:55], s13 offen sc1
  s_branch L_og_chk
L_og:
  s_and_b32 s11, s12, 15
  s_cmp_eq_u32 s11, 1
  s_cbranch_scc1 L_og_safe
  buffer_load_dwordx4 v[68:71], v19, s[52:55], s68 offen nt
  buffer_load_dwordx4 v[40:43], v18, s[52:55], s68 offen nt
L_og_chk:
  s_waitcnt vmcnt(1)
  v_max_f32_dpp v72, v68, v68 quad_perm:[2,3,0,1] row_mask:0xf bank_mask:0xf
  v_xor_b32 v69, s42, v69
  v_xor_b32 v71, s42, v71
  v_max_f32_dpp v72, v72, v72 quad_perm:[1,0,3,2] row_mask:0xf bank_mask:0xf
  v_or_b32 v69, v69, v71
  v_sub_f32 v72, v68, v72
  v_exp_f32 v72, v72
  s_waitcnt vmcnt(0)
  v_mul_f32 v73, v72, v70
  v_xor_b32 v40, s43, v40
  v_xor_b32 v41, s43, v41
  v_add_f32_dpp v73, v73, v73 quad_perm:[2,3,0,1] row_mask:0xf bank_mask:0xf
  v_xor_b32 v42, s43, v42
  v_xor_b32 v43, s43, v43
  v_add_f32_dpp v73, v73, v73 quad_perm:[1,0,3,2] row_mask:0xf bank_mask:0xf
  v_or3_b32 v37, v40, v41, v42
  v_rcp_f32 v73, v73
  v_or_b32 v37, v37, v43
  v_mul_f32 v40, v72, v40
  v_mul_f32 v41, v72, v41
  v_mul_f32 v42, v72, v42
  v_mul_f32 v43, v72, v43
  v_and_b32 v37, 0xff, v37
  v_or_b32 v37, v37, v69
  v_cmp_ne_u32 vcc, 0, v37
  v_add_f32_dpp v40, v40, v40 quad_perm:[2,3,0,1] row_mask:0xf bank_mask:0xf
  v_add_f32_dpp v41, v41, v41 quad_perm:[2,3,0,1] row_mask:0xf bank_mask:0xf
  v_add_f32_dpp v42, v42, v42 quad_perm:[2,3,0,1] row_mask:0xf bank_mask:0xf
  v_add_f32_dpp v43, v43, v43 quad_perm:[2,3,0,1] row_mask:0xf bank_mask:0xf
  v_add_f32_dpp v40, v40, v40 quad_perm:[1,0,3,2] row_mask:0xf bank_mask:0xf
  v_add_f32_dpp v41, v41, v41 quad_perm:[1,0,3,2] row_mask:0xf bank_mask:0xf
  v_add_f32_dpp v42, v42, v42 quad_perm:[1,0,3,2] row_mask:0xf bank_mask:0xf
  v_add_f32_dpp v43, v43, v43 quad_perm:[1,0,3,2] row_mask:0xf bank_mask:0xf
  s_sub_u32 s12, s12, 1
  s_cbranch_scc1 L_og_ok
  s_cbranch_vccnz L_og
L_og_ok:
  v_mul_f32 v40, v73, v40
  v_mul_f32 v41, v73, v41
  v_mul_f32 v42, v73, v42
  v_mul_f32 v43, v73, v43
  v_cvt_pk_bf16_f32 v40, v40, v40
  v_cvt_pk_bf16_f32 v41, v41, v41
  v_cvt_pk_bf16_f32 v42, v42, v42
  v_cvt_pk_bf16_f32 v43, v43, v43
  v_and_b32 v52, v40, v6
  v_and_b32 v53, v40, v7
  v_and_b32_dpp v54, v40, v8 row_half_mirror row_mask:0xf bank_mask:0xf
  v_and_b32_dpp v55, v40, v9 row_half_mirror row_mask:0xf bank_mask:0xf
  v_and_b32 v56, v41, v6
  v_and_b32 v57, v41, v7
  v_and_b32_dpp v58, v41, v8 row_half_mirror row_mask:0xf bank_mask:0xf
  v_and_b32_dpp v59, v41, v9 row_half_mirror row_mask:0xf bank_mask:0xf
  v_mfma_f32_16x16x32_bf16 v[32:35], v[52:55], v[192:195], 0
  v_and_b32 v52, v42, v6
  v_and_b32 v53, v42, v7
  v_and_b32_dpp v54, v42, v8 row_half_mirror row_mask:0xf bank_mask:0xf
  v_and_b32_dpp v55, v42, v9 row_half_mirror row_mask:0xf bank_mask:0xf
  v_mfma_f32_16x16x32_bf16 v[32:35], v[56:59], v[196:199], v[32:35]
  v_and_b32 v56, v43, v6
  v_and_b32 v57, v43, v7
  v_and_b32_dpp v58, v43, v8 row_half_mirror row_mask:0xf bank_mask:0xf
  v_and_b32_dpp v59, v43, v9 row_half_mirror row_mask:0xf bank_mask:0xf
  v_mfma_f32_16x16x32_bf16 v[32:35], v[52:55], v[200:203], v[32:35]
  v_and_b32_dpp v52, v40, v6 row_half_mirror row_mask:0xf bank_mask:0xf
  v_and_b32_dpp v53, v40, v7 row_half_mirror row_mask:0xf bank_mask:0xf
  v_and_b32 v54, v40, v8
  v_and_b32 v55, v40, v9
  v_mfma_f32_16x16x32_bf16 v[32:35], v[56:59], v[204:207], v[32:35]
  v_and_b32_dpp v56, v41, v6 row_half_mirror row_mask:0xf bank_mask:0xf
  v_and_b32_dpp v57, v41, v7 row_half_mirror row_mask:0xf bank_mask:0xf
  v_and_b32 v58, v41, v8
  v_and_b32 v59, v41, v9
  v_mfma_f32_16x16x32_bf16 v[32:35], v[52:55], v[208:211], v[32:35]
  v_and_b32_dpp v52, v42, v6 row_half_mirror row_mask:0xf bank_mask:0xf
  v_and_b32_dpp v53, v42, v7 row_half_mirror row_mask:0xf bank_mask:0xf
  v_and_b32 v54, v42, v8
  v_and_b32 v55, v42, v9
  v_mfma_f32_16x16x32_bf16 v[32:35], v[56:59], v[212:215], v[32:35]
  v_and_b32_dpp v56, v43, v6 row_half_mirror row_mask:0xf bank_mask:0xf
  v_and_b32_dpp v57, v43, v7 row_half_mirror row_mask:0xf bank_mask:0xf
  v_and_b32 v58, v43, v8
  v_and_b32 v59, v43, v9
  v_mfma_f32_16x16x32_bf16 v[32:35], v[52:55], v[216:219], v[32:35]
  s_nop 0
  v_mfma_f32_16x16x32_bf16 v[32:35], v[56:59], v[220:223], v[32:35]
  s_nop 7
  ds_write_b128 v31, v[32:35] offset:3136
  s_cmp_eq_u32 s10, 0
  s_cbranch_scc0 L_nosafe
  buffer_store_dwordx4 v[48:51], v28, s[52:55], s70 offen sc1
L_nosafe:
  s_waitcnt lgkmcnt(0)
  s_barrier
  s_cmp_lg_u32 s59, 0
  s_cbranch_scc1 L_final
  s_cmp_eq_u32 s10, 3
  s_cbranch_scc0 L_hend
  ds_read_b128 v[48:51], v24 offset:3136
  ds_read_b128 v[52:55], v24 offset:4160
  ds_read_b128 v[56:59], v24 offset:5184
  ds_read_b128 v[60:63], v24 offset:6208
  s_waitcnt lgkmcnt(2)
  v_add_f32 v48, v48, v52
  v_add_f32 v49, v49, v53
  v_add_f32 v50, v50, v54
  v_add_f32 v51, v51, v55
  s_waitcnt lgkmcnt(0)
  v_add_f32 v56, v56, v60
  v_add_f32 v57, v57, v61
  v_add_f32 v58, v58, v62
  v_add_f32 v59, v59, v63
  v_add_f32 v48, v48, v56
  v_add_f32 v49, v49, v57
  v_add_f32 v50, v50, v58
  v_add_f32 v51, v51, v59
  v_and_or_b32 v48, v48, s60, v92
  v_and_or_b32 v49, v49, s60, v92
  v_and_or_b32 v50, v50, s60, v92
  v_and_or_b32 v51, v51, s60, v92
  buffer_store_dwordx4 v[48:51], v27, s[52:55], s69 offen sc1
  s_cmp_eq_u32 s59, 0
  s_cbranch_scc1 L_hend
L_final:
  s_mov_b32 s12, 131072
L_fg:
  buffer_load_dwordx4 v[56:59], v29, s[52:55], s14 offen offset:0 sc1
  buffer_load_dwordx4 v[60:63], v29, s[52:55], s14 offen offset:1024 sc1
  buffer_load_dwordx4 v[64:67], v29, s[52:55], s14 offen offset:2048 sc1
  buffer_load_dwordx4 v[68:71], v89, s[52:55], s14 offen offset:3072 sc1
  buffer_load_dwordx4 v[96:99], v29, s[52:55], s15 offen offset:0 sc1
  buffer_load_dwordx4 v[100:103], v29, s[52:55], s15 offen offset:1024 sc1
  buffer_load_dwordx4 v[104:107], v29, s[52:55], s15 offen offset:2048 sc1
  buffer_load_dwordx4 v[108:111], v29, s[52:55], s15 offen offset:3072 sc1
  s_waitcnt vmcnt(4)
  v_or_b32 v68, v68, v30
  v_or_b32 v69, v69, v30
  v_or_b32 v70, v70, v30
  v_or_b32 v71, v71, v30
  v_xor_b32 v56, s43, v56
  v_xor_b32 v57, s43, v57
  v_xor_b32 v58, s43, v58
  v_xor_b32 v59, s43, v59
  v_xor_b32 v60, s43, v60
  v_xor_b32 v61, s43, v61
  v_xor_b32 v62, s43, v62
  v_xor_b32 v63, s43, v63
  v_xor_b32 v64, s43, v64
  v_xor_b32 v65, s43, v65
  v_xor_b32 v66, s43, v66
  v_xor_b32 v67, s43, v67
  v_xor_b32 v68, s43, v68
  v_xor_b32 v69, s43, v69
  v_xor_b32 v70, s43, v70
  v_xor_b32 v71, s43, v71
  v_or3_b32 v37, v56, v57, v58
  v_or3_b32 v37, v37, v59, v60
  v_or3_b32 v37, v37, v61, v62
  v_or3_b32 v37, v37, v63, v64
  v_or3_b32 v37, v37, v65, v66
  v_or3_b32 v37, v37, v67, v68
  v_or3_b32 v37, v37, v69, v70
  v_or_b32 v37, v37, v71
  v_and_b32 v37, 0xff, v37
  v_cmp_ne_u32 vcc, 0, v37
  s_waitcnt vmcnt(0)
  s_sub_u32 s12, s12, 1
  s_cbranch_scc1 L_fg_ok
  s_cbranch_vccnz L_fg
L_fg_ok:
  v_add_f32 v56, v56, v60
  v_add_f32 v64, v64, v68
  v_add_f32 v57, v57, v61
  v_add_f32 v65, v65, v69
  v_add_f32 v58, v58, v62
  v_add_f32 v66, v66, v70
  v_add_f32 v59, v59, v63
  v_add_f32 v67, v67, v71
  v_add_f32 v56, v56, v64
  v_add_f32 v57, v57, v65
  v_add_f32 v58, v58, v66
  v_add_f32 v59, v59, v67
  v_add_f32_dpp v56, v56, v56 row_ror:8 row_mask:0xf bank_mask:0xf
  v_add_f32_dpp v57, v57, v57 row_ror:8 row_mask:0xf bank_mask:0xf
  v_add_f32_dpp v58, v58, v58 row_ror:8 row_mask:0xf bank_mask:0xf
  v_add_f32_dpp v59, v59, v59 row_ror:8 row_mask:0xf bank_mask:0xf
  s_nop 0
  v_permlane16_swap_b32 v56, v57
  v_permlane16_swap_b32 v58, v59
  s_nop 0
  v_add_f32 v56, v56, v57
  v_add_f32 v58, v58, v59
  s_nop 1
  v_permlane32_swap_b32 v56, v58
  s_nop 1
  v_add_f32 v56, v56, v58
  v_cvt_pk_bf16_f32 v32, 0, v56
  v_add_f32 v32, v32, v91
  v_cvt_pk_bf16_f32 v32, 0, v32
  v_mul_f32 v33, 0xbfb8aa3b, v32
  v_exp_f32 v33, v33
  s_mov_b32 s12, 131072
  v_add_f32 v33, 1.0, v33
  v_rcp_f32 v33, v33
  s_nop 0
  v_mul_f32 v32, v32, v33
  v_cvt_pk_bf16_f32 v91, 0, v32
  s_branch L_yg_chk
L_yg:
  buffer_load_dwordx4 v[96:99], v29, s[52:55], s15 offen offset:0 sc1
  buffer_load_dwordx4 v[100:103], v29, s[52:55], s15 offen offset:1024 sc1
  buffer_load_dwordx4 v[104:107], v29, s[52:55], s15 offen offset:2048 sc1
  buffer_load_dwordx4 v[108:111], v29, s[52:55], s15 offen offset:3072 sc1
  s_waitcnt vmcnt(0)
L_yg_chk:
  v_xor_b32 v96, s43, v96
  v_xor_b32 v97, s43, v97
  v_xor_b32 v98, s43, v98
  v_xor_b32 v99, s43, v99
  v_xor_b32 v100, s43, v100
  v_xor_b32 v101, s43, v101
  v_xor_b32 v102, s43, v102
  v_xor_b32 v103, s43, v103
  v_xor_b32 v104, s43, v104
  v_xor_b32 v105, s43, v105
  v_xor_b32 v106, s43, v106
  v_xor_b32 v107, s43, v107
  v_xor_b32 v108, s43, v108
  v_xor_b32 v109, s43, v109
  v_xor_b32 v110, s43, v110
  v_xor_b32 v111, s43, v111
  v_or3_b32 v37, v96, v97, v98
  v_or3_b32 v37, v37, v99, v100
  v_or3_b32 v37, v37, v101, v102
  v_or3_b32 v37, v37, v103, v104
  v_or3_b32 v37, v37, v105, v106
  v_or3_b32 v37, v37, v107, v108
  v_or3_b32 v37, v37, v109, v110
  v_or_b32 v37, v37, v111
  v_and_b32 v37, 0xff, v37
  v_cmp_ne_u32 vcc, 0, v37
  s_sub_u32 s12, s12, 1
  s_cbranch_scc1 L_yg_ok
  s_cbranch_vccnz L_yg
L_yg_ok:
  v_add_f32 v96, v96, v100
  v_add_f32 v104, v104, v108
  v_add_f32 v97, v97, v101
  v_add_f32 v105, v105, v109
  v_add_f32 v98, v98, v102
  v_add_f32 v106, v106, v110
  v_add_f32 v99, v99, v103
  v_add_f32 v107, v107, v111
  v_add_f32 v96, v96, v104
  v_add_f32 v97, v97, v105
  v_add_f32 v98, v98, v106
  v_add_f32 v99, v99, v107
  v_add_f32_dpp v96, v96, v96 row_ror:8 row_mask:0xf bank_mask:0xf
  v_add_f32_dpp v97, v97, v97 row_ror:8 row_mask:0xf bank_mask:0xf
  v_add_f32_dpp v98, v98, v98 row_ror:8 row_mask:0xf bank_mask:0xf
  v_add_f32_dpp v99, v99, v99 row_ror:8 row_mask:0xf bank_mask:0xf
  s_nop 0
  v_permlane16_swap_b32 v96, v97
  v_permlane16_swap_b32 v98, v99
  s_nop 0
  v_add_f32 v96, v96, v97
  v_add_f32 v98, v98, v99
  s_nop 1
  v_permlane32_swap_b32 v96, v98
  s_nop 1
  v_add_f32 v96, v96, v98
  v_cvt_pk_bf16_f32 v32, 0, v96
  v_mul_f32 v32, v32, v91
  v_cvt_pk_bf16_f32 v32, 0, v32
  v_add_f32 v32, v32, v90
  v_cvt_pk_bf16_f32 v32, v32, v32
  buffer_store_short v32, v88, s[44:47], 0 offen
  s_cmp_eq_u32 s2, 216
  s_cbranch_scc0 L_nobump
  v_mov_b32 v33, s42
  s_mov_b32 s11, 1007616
  s_mov_b64 exec, 1
  buffer_store_dword v33, v21, s[52:55], s11 offen sc1
L_nobump:
L_hend:
L_exit:
  s_endpgm
.section .rodata,"a"
.p2align 6
.amdhsa_kernel recurrent_scan__mha_block_cached__dense_activation_squared_relu__decode_kernel
  .amdhsa_next_free_vgpr 256
  .amdhsa_next_free_sgpr 96
  .amdhsa_accum_offset 256
  .amdhsa_group_segment_fixed_size 0
  .amdhsa_kernarg_size 104
  .amdhsa_user_sgpr_count 2
  .amdhsa_user_sgpr_kernarg_segment_ptr 1
  .amdhsa_system_sgpr_workgroup_id_x 1
  .amdhsa_float_denorm_mode_32 3
.end_amdhsa_kernel
```
